```python
import torch

def _softmax(x, axis=-1):
    return torch.softmax(x, dim=axis)

def _gelu(x):
    return torch.nn.functional.gelu(x, approximate='tanh')

def _silu(x):
    return torch.nn.functional.silu(x)

def _sigmoid(x):
    return torch.sigmoid(x)

def _layernorm(x, axis=-1, eps=1e-05):
    m = x.mean(dim=axis, keepdim=True)
    v = x.var(dim=axis, keepdim=True, unbiased=False)
    return (x - m) / torch.sqrt(v + eps)

def _scatter_add(tgt, idx, src, axis=0):
    return tgt.clone().index_add_(axis, idx, src)

def _segment_sum(src, seg, n):
    out = torch.zeros((n,) + src.shape[1:], dtype=src.dtype)
    return out.index_add_(0, seg, src)

def _pad(x, pw):
    flat = tuple((v for pair in reversed(pw) for v in pair))
    return torch.nn.functional.pad(x, flat)
kernel_name = 'adaLN_cond__spectral_fnet__moe_arch_mod__prompt'

def setup_inputs():

    _w = lambda a: (lambda t: t.to(torch.bfloat16) if t.is_floating_point() else t)(torch.as_tensor(a))

    def _A_setup():
        B, S, D = (1, 2048, 448)
        ns = torch.arange(S)[:, None] * torch.arange(S)[None, :]
        nd = torch.arange(D)[:, None] * torch.arange(D)[None, :]
        Ws_re = torch.cos(-2.0 * torch.pi * ns / S).to(float)
        Ws_im = torch.sin(-2.0 * torch.pi * ns / S).to(float)
        Wd_re = torch.cos(-2.0 * torch.pi * nd / D).to(float)
        Wd_im = torch.sin(-2.0 * torch.pi * nd / D).to(float)
        return {'x': _w((lambda *s: torch.randn(*s, dtype=torch.bfloat16) * 0.05)(B, S, D)), 'dft_seq_re': _w(Ws_re), 'dft_seq_im': _w(Ws_im), 'dft_hid_re': _w(Wd_re), 'dft_hid_im': _w(Wd_im)}
    _A_in = _A_setup()

    def _B_setup():
        B, S, D, F, C = (1, 2048, 448, 1792, 1)
        return {'x': _w((lambda *s: torch.randn(*s, dtype=torch.bfloat16) * 0.05)(B, S, D)), 'w_r': _w((lambda *s: torch.randn(*s, dtype=torch.bfloat16) * 3.2)(D)), 'w_gate': _w((lambda *s: torch.randn(*s, dtype=torch.bfloat16) * 0.8)(D, F)), 'w_up': _w((lambda *s: torch.randn(*s, dtype=torch.bfloat16) * 0.8)(D, F)), 'w_down': _w((lambda *s: torch.randn(*s, dtype=torch.bfloat16) * 0.8)(F, D))}
    _B_in = _B_setup()
    return {'A_x': _A_in['x'], 'A_dft_seq_re': _A_in['dft_seq_re'], 'A_dft_seq_im': _A_in['dft_seq_im'], 'A_dft_hid_re': _A_in['dft_hid_re'], 'A_dft_hid_im': _A_in['dft_hid_im'], 'B_x': _B_in['x'], 'B_w_r': _B_in['w_r'], 'B_w_gate': _B_in['w_gate'], 'B_w_up': _B_in['w_up'], 'B_w_down': _B_in['w_down'], 'c': _w((lambda *s: torch.randn(*s, dtype=torch.bfloat16) * 0.1)(1, 448) * 8.0), 'w_mod': _w((lambda *s: torch.randn(*s, dtype=torch.bfloat16) * 0.1)(448, 6 * 448) * 448 ** (-0.5) * 8.0)}

def reference(A_x, A_dft_seq_re, A_dft_seq_im, A_dft_hid_re, A_dft_hid_im, B_x, B_w_r, B_w_gate, B_w_up, B_w_down, c, w_mod):

    def _A_ref(x, dft_seq_re, dft_seq_im, dft_hid_re, dft_hid_im):
        a = torch.einsum('bsd,ed->bse', x, dft_hid_re)
        b = torch.einsum('bsd,ed->bse', x, dft_hid_im)
        y = torch.einsum('ts,bse->bte', dft_seq_re, a) - torch.einsum('ts,bse->bte', dft_seq_im, b)
        return y

    def _B_ref(x, w_r, w_gate, w_up, w_down):
        B, S, D = x.shape
        C = 1
        r = x @ w_r
        idx = torch.argsort(-r, axis=-1)[:, :C]
        idx_e = (lambda x, n, axis: torch.repeat_interleave(x, n, dim=axis))(idx.reshape(B, C, 1), D, axis=2)
        x_sel = (lambda x, i, axis: torch.take_along_dim(x, i, dim=axis))(x, idx_e, axis=1)
        g = _silu(x_sel @ w_gate)
        u = x_sel @ w_up
        y = g * u @ w_down
        r_sel = _sigmoid((lambda x, i, axis: torch.take_along_dim(x, i, dim=axis))(r, idx, axis=1))
        y = y * r_sel.reshape(B, C, 1)
        b_off = (torch.arange(B) * S).reshape(B, 1)
        flat_idx = (idx + b_off).reshape(B * C)
        zero = (x * 0.0).reshape(B * S, D)
        upd = _scatter_add(zero, flat_idx, y.reshape(B * C, D), axis=0)
        return x + upd.reshape(B, S, D)
    x = A_x
    mod = (_silu(c) @ w_mod).reshape(c.shape[0], 6, 1, -1)
    sa, ca, ga, sb, cb, gb = (mod[:, 0].clone(), mod[:, 1].clone(), mod[:, 2].clone(), mod[:, 3].clone(), mod[:, 4].clone(), mod[:, 5].clone())
    h = _layernorm(x, axis=-1) * (1 + ca) + sa
    x = x + ga * _A_ref(h, A_dft_seq_re, A_dft_seq_im, A_dft_hid_re, A_dft_hid_im)
    h = _layernorm(x, axis=-1) * (1 + cb) + sb
    x = x + gb * _B_ref(h, B_w_r, B_w_gate, B_w_up, B_w_down)
    return x
```

```asm
; @launch grid=(256,1,1) block=(512,1,1) lds=120512
.amdgcn_target "amdgcn-amd-amdhsa--gfx950"
.text
.globl adaLN_cond__spectral_fnet__moe_arch_mod__prompt_kernel
.p2align 8
.type adaLN_cond__spectral_fnet__moe_arch_mod__prompt_kernel,@function
adaLN_cond__spectral_fnet__moe_arch_mod__prompt_kernel:
    s_load_dwordx2 s[4:5], s[0:1], 0
    s_load_dwordx4 s[16:19], s[0:1], 80
    s_load_dwordx2 s[6:7], s[0:1], 112
    s_load_dwordx8 s[8:15], s[0:1], 48
    s_load_dwordx2 s[20:21], s[0:1], 96
    v_lshrrev_b32 v4, 6, v0
    v_and_b32 v1, 63, v0
    v_readfirstlane_b32 s23, v4
    v_lshrrev_b32 v2, 4, v1
    v_and_b32 v3, 15, v1
    s_lshr_b32 s24, s2, 3
    s_and_b32 s25, s2, 7
    s_cmp_ge_u32 s24, 16
    s_cbranch_scc1 adaLN_cond__spectral_fnet__moe_arch_mod__prompt_kernel_DISP
adaLN_cond__spectral_fnet__moe_arch_mod__prompt_kernel_S1:
    s_lshr_b32 s31, s24, 2
    s_lshl_b32 s26, s25, 2
    s_add_u32 s31, s31, s26
    s_and_b32 s30, s24, 3
    s_lshl_b32 s30, s30, 1
    s_mul_i32 s28, s31, 896
    s_lshl_b32 s26, s30, 7
    s_add_u32 s52, s28, s26
    s_add_u32 s27, s28, 896
    s_add_u32 s53, s52, 128
    s_cmp_ge_u32 s53, s27
    s_cselect_b32 s53, s28, s53
    s_add_u32 s54, s53, 128
    s_cmp_ge_u32 s54, s27
    s_cselect_b32 s54, s28, s54
    s_add_u32 s55, s54, 128
    s_cmp_ge_u32 s55, s27
    s_cselect_b32 s55, s28, s55
    s_add_u32 s56, s55, 128
    s_cmp_ge_u32 s56, s27
    s_cselect_b32 s56, s28, s56
    s_add_u32 s57, s56, 128
    s_cmp_ge_u32 s57, s27
    s_cselect_b32 s57, s28, s57
    s_add_u32 s58, s57, 128
    s_cmp_ge_u32 s58, s27
    s_cselect_b32 s58, s28, s58
    s_add_u32 s26, s23, s30
    s_and_b32 s26, s26, 7
    s_lshl_b32 s26, s26, 3
    v_lshrrev_b32 v180, 3, v1
    v_add_u32 v180, s26, v180
    v_mul_u32_u24 v4, 28672, v180
    v_and_b32 v5, 7, v0
    v_lshl_add_u32 v6, v5, 4, v4
    s_waitcnt lgkmcnt(0)
    s_mov_b32 s36, s4
    s_mov_b32 s37, s5
    s_mov_b32 s38, 0x1c0000
    s_mov_b32 s39, 0x00020000
    s_cmp_ge_u32 s23, 4
    s_cbranch_scc1 adaLN_cond__spectral_fnet__moe_arch_mod__prompt_kernel_x16
    buffer_load_dwordx4 v[104:107], v6, s[36:39], s52 offen
    buffer_load_dwordx4 v[108:111], v6, s[36:39], s53 offen
    buffer_load_dwordx4 v[112:115], v6, s[36:39], s54 offen
    buffer_load_dwordx4 v[116:119], v6, s[36:39], s55 offen
    buffer_load_dwordx4 v[120:123], v6, s[36:39], s56 offen
    buffer_load_dwordx4 v[124:127], v6, s[36:39], s57 offen
    buffer_load_dwordx4 v[128:131], v6, s[36:39], s58 offen
    s_branch adaLN_cond__spectral_fnet__moe_arch_mod__prompt_kernel_x16
adaLN_cond__spectral_fnet__moe_arch_mod__prompt_kernel_DISP:
    s_cmp_lg_u32 s24, 16
    s_cbranch_scc1 adaLN_cond__spectral_fnet__moe_arch_mod__prompt_kernel_cpf8
    s_sub_u32 s26, s23, 4
    s_cmp_ge_u32 s26, 2
    s_cbranch_scc1 adaLN_cond__spectral_fnet__moe_arch_mod__prompt_kernel_cpf8
    s_getpc_b64 s[40:41]
adaLN_cond__spectral_fnet__moe_arch_mod__prompt_kernel_cpf8a:
    s_sub_u32 s40, s40, adaLN_cond__spectral_fnet__moe_arch_mod__prompt_kernel_cpf8a-adaLN_cond__spectral_fnet__moe_arch_mod__prompt_kernel
    s_subb_u32 s41, s41, 0
    s_lshl_b32 s26, s26, 13
    v_lshlrev_b32 v4, 7, v1
    v_add_u32 v4, s26, v4
    v_min_u32 v4, adaLN_cond__spectral_fnet__moe_arch_mod__prompt_kernel_end1-adaLN_cond__spectral_fnet__moe_arch_mod__prompt_kernel, v4
    global_load_dword v5, v4, s[40:41]
adaLN_cond__spectral_fnet__moe_arch_mod__prompt_kernel_cpf8:
    s_cmp_ge_u32 s2, 256
    s_cbranch_scc1 adaLN_cond__spectral_fnet__moe_arch_mod__prompt_kernel_end1
    s_cmp_lt_u32 s24, 23
    s_cbranch_scc1 adaLN_cond__spectral_fnet__moe_arch_mod__prompt_kernel_G3
    s_sub_u32 s31, s2, 216
    s_cmp_ge_u32 s24, 27
    s_cbranch_scc1 adaLN_cond__spectral_fnet__moe_arch_mod__prompt_kernel_mod2
    s_cmp_lg_u32 s25, 7
    s_cbranch_scc1 adaLN_cond__spectral_fnet__moe_arch_mod__prompt_kernel_D4
    s_add_u32 s31, s24, 17
    s_cmp_ge_u32 s24, 25
    s_cbranch_scc1 adaLN_cond__spectral_fnet__moe_arch_mod__prompt_kernel_sp5
    s_branch adaLN_cond__spectral_fnet__moe_arch_mod__prompt_kernel_mod2
adaLN_cond__spectral_fnet__moe_arch_mod__prompt_kernel_x16:
    s_add_u32 s26, s6, 1867776
    s_addc_u32 s27, s7, 0
    s_load_dword s22, s[26:27], 0
    s_mov_b32 s40, s6
    s_mov_b32 s41, s7
    s_mov_b32 s42, 0x300000
    s_mov_b32 s43, 0x00020000
    s_lshl_b32 s33, s31, 2
    s_lshr_b32 s26, s30, 1
    s_add_u32 s33, s33, s26
    s_mov_b32 s32, 0x3f803f80
    s_and_b32 s26, s23, 1
    s_lshl_b32 s26, s26, 4
    v_add_u32 v7, s26, v3
    v_cvt_f32_u32 v84, v7
    s_bitcmp1_b32 s23, 1
    s_cselect_b32 s26, 0x3e800000, 0
    s_cselect_b32 s27, 0x42000000, 0
    v_mov_b32 v85, s26
    v_mov_b32 v4, s27
    v_cmp_eq_u32 vcc, 0, v7
    s_nop 1
    v_cndmask_b32 v84, v84, v4, vcc
    v_cndmask_b32 v85, v85, 0, vcc
    v_mul_f32 v84, 0x3c800000, v84
    v_lshlrev_b32 v4, 2, v2
    v_cvt_f32_u32 v4, v4
    v_fmac_f32 v85, v84, v4
    v_fmamk_f32 v136, v84, 0x00000000, v85
    v_fmamk_f32 v137, v84, 0x3f800000, v85
    v_fmamk_f32 v138, v84, 0x40000000, v85
    v_fmamk_f32 v139, v84, 0x40400000, v85
    v_fmamk_f32 v140, v84, 0x41800000, v85
    v_fmamk_f32 v141, v84, 0x41880000, v85
    v_fmamk_f32 v142, v84, 0x41900000, v85
    v_fmamk_f32 v143, v84, 0x41980000, v85
    v_fmamk_f32 v144, v84, 0x42000000, v85
    v_fmamk_f32 v145, v84, 0x42040000, v85
    v_fmamk_f32 v146, v84, 0x42080000, v85
    v_fmamk_f32 v147, v84, 0x420c0000, v85
    v_fmamk_f32 v148, v84, 0x42400000, v85
    v_fmamk_f32 v149, v84, 0x42440000, v85
    v_fmamk_f32 v150, v84, 0x42480000, v85
    v_fmamk_f32 v151, v84, 0x424c0000, v85
    v_cos_f32 v136, v136
    v_cos_f32 v137, v137
    v_cos_f32 v138, v138
    v_cos_f32 v139, v139
    v_cos_f32 v140, v140
    v_cos_f32 v141, v141
    v_cos_f32 v142, v142
    v_cos_f32 v143, v143
    v_cos_f32 v144, v144
    v_cos_f32 v145, v145
    v_cos_f32 v146, v146
    v_cos_f32 v147, v147
    v_cos_f32 v148, v148
    v_cos_f32 v149, v149
    v_cos_f32 v150, v150
    v_cos_f32 v151, v151
    v_cvt_pk_bf16_f32 v168, v136, v137
    v_cvt_pk_bf16_f32 v169, v138, v139
    v_cvt_pk_bf16_f32 v170, v140, v141
    v_cvt_pk_bf16_f32 v171, v142, v143
    v_cvt_pk_bf16_f32 v172, v144, v145
    v_cvt_pk_bf16_f32 v173, v146, v147
    v_cvt_pk_bf16_f32 v174, v148, v149
    v_cvt_pk_bf16_f32 v175, v150, v151
    s_mul_i32 s33, s33, 32
    s_add_u32 s33, s33, 2621440
    v_mul_u32_u24 v102, 24576, v1
    v_mov_b32 v176, 0
    v_mov_b32 v177, 0
    v_mov_b32 v178, 0
    v_mov_b32 v179, 0
    v_mov_b32 v4, 105984
    ds_write_b128 v4, v[176:179]
    v_mul_u32_u24 v181, 288, v180
    v_and_b32 v5, 7, v0
    v_lshl_add_u32 v181, v5, 4, v181
    v_lshrrev_b32 v4, 2, v1
    v_mul_u32_u24 v182, 288, v4
    v_and_b32 v7, 3, v1
    v_lshl_add_u32 v182, v7, 3, v182
    s_lshr_b32 s26, s23, 2
    s_lshl_b32 s26, s26, 7
    v_add_u32 v182, s26, v182
    v_lshrrev_b32 v4, 3, v1
    v_mul_u32_u24 v183, 57344, v4
    v_lshl_add_u32 v183, v5, 4, v183
    s_mul_i32 s29, s23, 2304
    s_add_u32 s29, s29, 18432
    v_mul_u32_u24 v184, 144, v3
    v_lshl_add_u32 v184, v2, 3, v184
    v_add_u32 v184, s29, v184
    v_mul_u32_u24 v185, 144, v4
    v_lshl_add_u32 v185, v5, 4, v185
    v_add_u32 v185, s29, v185
    s_bfe_u32 s27, s23, 0x10001
    s_mul_i32 s27, s27, 28672
    s_add_u32 s64, s52, s27
    s_add_u32 s64, s64, s26
    s_and_b32 s27, s23, 1
    s_mul_i32 s27, s27, 917504
    s_add_u32 s64, s64, s27
    s_lshr_b32 s26, s23, 2
    s_add_u32 s26, s26, s30
    s_cmp_eq_u32 s26, 7
    s_cselect_b32 s64, 1072693248, s64
    s_add_u32 s65, s64, 458752
    s_lshr_b32 s26, s24, 2
    s_lshl_b32 s26, s26, 3
    s_add_u32 s59, s25, s26
    s_bfe_u32 s61, s24, 0x10001
    s_sub_u32 s26, 64, s59
    s_cmp_eq_u32 s59, 0
    s_cselect_b32 s26, 32, s26
    s_cmp_eq_u32 s61, 1
    s_cselect_b32 s60, s26, s59
    s_and_b32 s26, s24, 1
    s_lshl_b32 s26, s26, 10
    s_add_u32 s60, s60, s26
    s_lshl_b32 s26, s23, 7
    s_add_u32 s26, s26, s60
    s_mul_i32 s63, s26, 896
    s_sub_u32 s66, 2047, s26
    s_mul_i32 s62, s23, 1792
    s_add_u32 s62, s62, 106048
    v_lshlrev_b32 v97, 4, v1
    v_mov_b32 v5, 1072693248
    s_mov_b32 s48, s8
    s_mov_b32 s49, s9
    s_mov_b32 s50, 0x380
    s_mov_b32 s51, 0x00020000
    s_cmp_eq_u32 s23, 7
    s_cselect_b32 s50, s50, 0
    v_lshlrev_b32 v101, 3, v1
    v_add_u32 v240, 512, v101
    v_cmp_gt_u32 vcc, 48, v1
    s_nop 1
    v_cndmask_b32 v240, v5, v240, vcc
    s_cmp_lt_u32 s23, 4
    s_cbranch_scc1 adaLN_cond__spectral_fnet__moe_arch_mod__prompt_kernel_x27
    buffer_load_dwordx4 v[104:107], v6, s[36:39], s52 offen
    buffer_load_dwordx4 v[108:111], v6, s[36:39], s53 offen
    buffer_load_dwordx4 v[112:115], v6, s[36:39], s54 offen
    buffer_load_dwordx4 v[116:119], v6, s[36:39], s55 offen
    buffer_load_dwordx4 v[120:123], v6, s[36:39], s56 offen
    buffer_load_dwordx4 v[124:127], v6, s[36:39], s57 offen
    buffer_load_dwordx4 v[128:131], v6, s[36:39], s58 offen
adaLN_cond__spectral_fnet__moe_arch_mod__prompt_kernel_x27:
    s_setprio 2
    s_waitcnt vmcnt(6)
    v_lshlrev_b32 v136, 16, v104
    v_and_b32 v137, 0xffff0000, v104
    v_lshlrev_b32 v138, 16, v105
    v_and_b32 v139, 0xffff0000, v105
    v_lshlrev_b32 v140, 16, v106
    v_and_b32 v141, 0xffff0000, v106
    v_lshlrev_b32 v142, 16, v107
    v_and_b32 v143, 0xffff0000, v107
    v_dot2c_f32_bf16 v176, s32, v104
    v_dot2c_f32_bf16 v178, v104, v104
    v_dot2c_f32_bf16 v177, s32, v105
    v_dot2c_f32_bf16 v179, v105, v105
    v_dot2c_f32_bf16 v176, s32, v106
    v_dot2c_f32_bf16 v178, v106, v106
    v_dot2c_f32_bf16 v177, s32, v107
    v_dot2c_f32_bf16 v179, v107, v107
    s_waitcnt vmcnt(5)
    v_lshlrev_b32 v144, 16, v108
    v_and_b32 v145, 0xffff0000, v108
    v_lshlrev_b32 v146, 16, v109
    v_and_b32 v147, 0xffff0000, v109
    v_lshlrev_b32 v148, 16, v110
    v_and_b32 v149, 0xffff0000, v110
    v_lshlrev_b32 v150, 16, v111
    v_and_b32 v151, 0xffff0000, v111
    v_dot2c_f32_bf16 v176, s32, v108
    v_dot2c_f32_bf16 v178, v108, v108
    v_dot2c_f32_bf16 v177, s32, v109
    v_dot2c_f32_bf16 v179, v109, v109
    v_dot2c_f32_bf16 v176, s32, v110
    v_dot2c_f32_bf16 v178, v110, v110
    v_dot2c_f32_bf16 v177, s32, v111
    v_dot2c_f32_bf16 v179, v111, v111
    s_waitcnt vmcnt(4)
    v_dot2c_f32_bf16 v176, s32, v112
    v_dot2c_f32_bf16 v178, v112, v112
    v_dot2c_f32_bf16 v177, s32, v113
    v_dot2c_f32_bf16 v179, v113, v113
    v_dot2c_f32_bf16 v176, s32, v114
    v_dot2c_f32_bf16 v178, v114, v114
    v_dot2c_f32_bf16 v177, s32, v115
    v_dot2c_f32_bf16 v179, v115, v115
    s_waitcnt vmcnt(3)
    v_dot2c_f32_bf16 v176, s32, v116
    v_dot2c_f32_bf16 v178, v116, v116
    v_dot2c_f32_bf16 v177, s32, v117
    v_dot2c_f32_bf16 v179, v117, v117
    v_dot2c_f32_bf16 v176, s32, v118
    v_dot2c_f32_bf16 v178, v118, v118
    v_dot2c_f32_bf16 v177, s32, v119
    v_dot2c_f32_bf16 v179, v119, v119
    s_waitcnt vmcnt(2)
    v_dot2c_f32_bf16 v176, s32, v120
    v_dot2c_f32_bf16 v178, v120, v120
    v_dot2c_f32_bf16 v177, s32, v121
    v_dot2c_f32_bf16 v179, v121, v121
    v_dot2c_f32_bf16 v176, s32, v122
    v_dot2c_f32_bf16 v178, v122, v122
    v_dot2c_f32_bf16 v177, s32, v123
    v_dot2c_f32_bf16 v179, v123, v123
    s_waitcnt vmcnt(1)
    v_dot2c_f32_bf16 v176, s32, v124
    v_dot2c_f32_bf16 v178, v124, v124
    v_dot2c_f32_bf16 v177, s32, v125
    v_dot2c_f32_bf16 v179, v125, v125
    v_dot2c_f32_bf16 v176, s32, v126
    v_dot2c_f32_bf16 v178, v126, v126
    v_dot2c_f32_bf16 v177, s32, v127
    v_dot2c_f32_bf16 v179, v127, v127
    s_waitcnt vmcnt(0)
    v_dot2c_f32_bf16 v176, s32, v128
    v_dot2c_f32_bf16 v178, v128, v128
    v_dot2c_f32_bf16 v177, s32, v129
    v_dot2c_f32_bf16 v179, v129, v129
    v_dot2c_f32_bf16 v176, s32, v130
    v_dot2c_f32_bf16 v178, v130, v130
    v_dot2c_f32_bf16 v177, s32, v131
    v_dot2c_f32_bf16 v179, v131, v131
    s_mov_b32 m0, s62
    s_add_u32 s26, s63, 56448
    s_bfm_b64 exec, 56, 0
    buffer_load_dwordx4 v97, s[36:39], s63 offen  lds
    buffer_load_dwordx4 v97, s[36:39], s26 offen offset:896  lds
    s_mov_b64 exec, -1
    buffer_load_dwordx2 v[68:69], v101, s[48:51], 0 offen
    buffer_load_dwordx2 v[70:71], v240, s[48:51], 0 offen
    v_add_f32 v176, v176, v177
    v_add_f32 v178, v178, v179
    s_nop 0
    v_add_f32_dpp v176, v176, v176 quad_perm:[1,0,3,2] row_mask:0xf bank_mask:0xf
    v_add_f32_dpp v178, v178, v178 quad_perm:[1,0,3,2] row_mask:0xf bank_mask:0xf
    s_nop 0
    v_add_f32_dpp v176, v176, v176 quad_perm:[2,3,0,1] row_mask:0xf bank_mask:0xf
    v_add_f32_dpp v178, v178, v178 quad_perm:[2,3,0,1] row_mask:0xf bank_mask:0xf
    s_nop 0
    v_add_f32_dpp v176, v176, v176 row_half_mirror row_mask:0xf bank_mask:0xf
    v_add_f32_dpp v178, v178, v178 row_half_mirror row_mask:0xf bank_mask:0xf
    v_mul_f32 v176, 0x3b124925, v176
    v_mul_f32 v178, 0x3b124925, v178
    v_fma_f32 v178, -v176, v176, v178
    v_max_f32 v178, 0, v178
    v_add_f32 v178, 0x3727c5ac, v178
    v_rsq_f32 v178, v178
    s_nop 0
    v_mul_f32 v176, v176, v178
    v_fma_f32 v136, v136, v178, -v176
    v_fma_f32 v137, v137, v178, -v176
    v_fma_f32 v138, v138, v178, -v176
    v_fma_f32 v139, v139, v178, -v176
    v_fma_f32 v140, v140, v178, -v176
    v_fma_f32 v141, v141, v178, -v176
    v_fma_f32 v142, v142, v178, -v176
    v_fma_f32 v143, v143, v178, -v176
    v_cvt_pk_bf16_f32 v104, v136, v137
    v_cvt_pk_bf16_f32 v105, v138, v139
    v_cvt_pk_bf16_f32 v106, v140, v141
    v_cvt_pk_bf16_f32 v107, v142, v143
    ds_write_b128 v181, v[104:107] offset:0
    v_fma_f32 v144, v144, v178, -v176
    v_fma_f32 v145, v145, v178, -v176
    v_fma_f32 v146, v146, v178, -v176
    v_fma_f32 v147, v147, v178, -v176
    v_fma_f32 v148, v148, v178, -v176
    v_fma_f32 v149, v149, v178, -v176
    v_fma_f32 v150, v150, v178, -v176
    v_fma_f32 v151, v151, v178, -v176
    v_cvt_pk_bf16_f32 v108, v144, v145
    v_cvt_pk_bf16_f32 v109, v146, v147
    v_cvt_pk_bf16_f32 v110, v148, v149
    v_cvt_pk_bf16_f32 v111, v150, v151
    ds_write_b128 v181, v[108:111] offset:128
    s_waitcnt lgkmcnt(0)
    s_barrier
    ds_read_b64_tr_b16 v[104:105], v182 offset:0
    ds_read_b64_tr_b16 v[106:107], v182 offset:4608
    ds_read_b64_tr_b16 v[108:109], v182 offset:9216
    ds_read_b64_tr_b16 v[110:111], v182 offset:13824
    ds_read_b64_tr_b16 v[112:113], v182 offset:32
    ds_read_b64_tr_b16 v[114:115], v182 offset:4640
    ds_read_b64_tr_b16 v[116:117], v182 offset:9248
    ds_read_b64_tr_b16 v[118:119], v182 offset:13856
    ds_read_b64_tr_b16 v[120:121], v182 offset:64
    ds_read_b64_tr_b16 v[122:123], v182 offset:4672
    ds_read_b64_tr_b16 v[124:125], v182 offset:9280
    ds_read_b64_tr_b16 v[126:127], v182 offset:13888
    ds_read_b64_tr_b16 v[128:129], v182 offset:96
    ds_read_b64_tr_b16 v[130:131], v182 offset:4704
    ds_read_b64_tr_b16 v[132:133], v182 offset:9312
    ds_read_b64_tr_b16 v[134:135], v182 offset:13920
    s_mul_i32 s22, s22, 0x9E3779B1
    s_add_u32 s22, s22, 0x7F4A7C15
    v_mov_b32 v8, s22
    v_mov_b32 v9, s22
    v_mov_b32 v10, s22
    v_mov_b32 v11, s22
    s_waitcnt lgkmcnt(12)
    v_mfma_f32_16x16x32_bf16 v[136:139], v[104:107], v[168:171], 0
    v_mfma_f32_16x16x32_bf16 v[136:139], v[108:111], v[172:175], v[136:139]
    s_waitcnt lgkmcnt(8)
    v_mfma_f32_16x16x32_bf16 v[140:143], v[112:115], v[168:171], 0
    v_mfma_f32_16x16x32_bf16 v[140:143], v[116:119], v[172:175], v[140:143]
    s_waitcnt lgkmcnt(4)
    v_mfma_f32_16x16x32_bf16 v[144:147], v[120:123], v[168:171], 0
    v_mfma_f32_16x16x32_bf16 v[144:147], v[124:127], v[172:175], v[144:147]
    s_waitcnt lgkmcnt(0)
    v_mfma_f32_16x16x32_bf16 v[148:151], v[128:131], v[168:171], 0
    v_mfma_f32_16x16x32_bf16 v[148:151], v[132:135], v[172:175], v[148:151]
    v_cvt_pk_bf16_f32 v152, v136, v137
    v_cvt_pk_bf16_f32 v153, v138, v139
    ds_write_b64 v184, v[152:153] offset:0
    v_cvt_pk_bf16_f32 v154, v140, v141
    v_cvt_pk_bf16_f32 v155, v142, v143
    ds_write_b64 v184, v[154:155] offset:32
    v_cvt_pk_bf16_f32 v156, v144, v145
    v_cvt_pk_bf16_f32 v157, v146, v147
    ds_write_b64 v184, v[156:157] offset:64
    v_cvt_pk_bf16_f32 v158, v148, v149
    v_cvt_pk_bf16_f32 v159, v150, v151
    ds_write_b64 v184, v[158:159] offset:96
    s_waitcnt lgkmcnt(0)
    ds_read_b128 v[104:107], v185
    ds_read_b128 v[108:111], v185 offset:1152
    s_waitcnt lgkmcnt(1)
    buffer_store_dwordx4 v[104:107], v183, s[40:43], s64 offen sc1
    s_waitcnt lgkmcnt(0)
    buffer_store_dwordx4 v[108:111], v183, s[40:43], s65 offen sc1
    s_setprio 0
    v_cvt_f32_u32 v84, v3
    v_mul_f32 v84, 0x3d124925, v84
    v_lshlrev_b32 v4, 3, v2
    s_and_b32 s26, s23, 4
    v_add_u32 v4, s26, v4
    v_xor_b32 v7, 4, v4
    v_cvt_f32_u32 v4, v4
    v_cvt_f32_u32 v7, v7
    v_cmp_gt_u32 vcc, 12, v3
    v_mul_f32 v152, v4, v84
    v_mul_f32 v156, v7, v84
    v_fmamk_f32 v153, v84, 0x3f800000, v152
    v_fmamk_f32 v154, v84, 0x40000000, v152
    v_fmamk_f32 v155, v84, 0x40400000, v152
    v_fmamk_f32 v157, v84, 0x3f800000, v156
    v_fmamk_f32 v158, v84, 0x40000000, v156
    v_fmamk_f32 v159, v84, 0x40400000, v156
    v_sin_f32 v160, v152
    v_cos_f32 v152, v152
    v_sin_f32 v161, v153
    v_cos_f32 v153, v153
    v_sin_f32 v162, v154
    v_cos_f32 v154, v154
    v_sin_f32 v163, v155
    v_cos_f32 v155, v155
    v_sin_f32 v164, v156
    v_cos_f32 v156, v156
    v_sin_f32 v165, v157
    v_cos_f32 v157, v157
    v_sin_f32 v166, v158
    v_cos_f32 v158, v158
    v_sin_f32 v167, v159
    v_cos_f32 v159, v159
    v_cvt_pk_bf16_f32 v28, v152, v153
    v_cvt_pk_bf16_f32 v32, -v160, -v161
    v_cvt_pk_bf16_f32 v29, v154, v155
    v_cvt_pk_bf16_f32 v33, -v162, -v163
    v_cvt_pk_bf16_f32 v30, v156, v157
    v_cvt_pk_bf16_f32 v34, -v164, -v165
    v_cvt_pk_bf16_f32 v31, v158, v159
    v_cvt_pk_bf16_f32 v35, -v166, -v167
    v_add_f32 v84, 0x3f124925, v84
    v_mul_f32 v152, v4, v84
    v_mul_f32 v156, v7, v84
    v_fmamk_f32 v153, v84, 0x3f800000, v152
    v_fmamk_f32 v154, v84, 0x40000000, v152
    v_fmamk_f32 v155, v84, 0x40400000, v152
    v_fmamk_f32 v157, v84, 0x3f800000, v156
    v_fmamk_f32 v158, v84, 0x40000000, v156
    v_fmamk_f32 v159, v84, 0x40400000, v156
    v_sin_f32 v160, v152
    v_cos_f32 v152, v152
    v_sin_f32 v161, v153
    v_cos_f32 v153, v153
    v_sin_f32 v162, v154
    v_cos_f32 v154, v154
    v_sin_f32 v163, v155
    v_cos_f32 v155, v155
    v_sin_f32 v164, v156
    v_cos_f32 v156, v156
    v_sin_f32 v165, v157
    v_cos_f32 v157, v157
    v_sin_f32 v166, v158
    v_cos_f32 v158, v158
    v_sin_f32 v167, v159
    v_cos_f32 v159, v159
    v_cvt_pk_bf16_f32 v36, v152, v153
    v_cvt_pk_bf16_f32 v40, -v160, -v161
    v_cvt_pk_bf16_f32 v37, v154, v155
    v_cvt_pk_bf16_f32 v41, -v162, -v163
    v_cvt_pk_bf16_f32 v38, v156, v157
    v_cvt_pk_bf16_f32 v42, -v164, -v165
    v_cvt_pk_bf16_f32 v39, v158, v159
    v_cvt_pk_bf16_f32 v43, -v166, -v167
    v_cndmask_b32 v36, 0, v36, vcc
    v_cndmask_b32 v37, 0, v37, vcc
    v_cndmask_b32 v38, 0, v38, vcc
    v_cndmask_b32 v39, 0, v39, vcc
    v_cndmask_b32 v40, 0, v40, vcc
    v_cndmask_b32 v41, 0, v41, vcc
    v_cndmask_b32 v42, 0, v42, vcc
    v_cndmask_b32 v43, 0, v43, vcc
    s_mov_b32 s44, s20
    s_mov_b32 s45, s21
    s_mov_b32 s46, 0x1c0000
    s_mov_b32 s47, 0x00020000
    s_and_b32 s30, s25, 7
    s_mul_i32 s30, s30, 24576
    s_add_u32 s30, s30, 2621440
    v_mul_u32_u24 v6, 32, v1
    s_waitcnt vmcnt(0)
    s_barrier
    s_cmp_lg_u32 s23, 0
    s_cbranch_scc1 adaLN_cond__spectral_fnet__moe_arch_mod__prompt_kernel_nf9
    s_mov_b64 exec, 0xff
    buffer_store_dword v8, v102, s[40:43], s33 offen sc1
    s_mov_b64 exec, -1
adaLN_cond__spectral_fnet__moe_arch_mod__prompt_kernel_nf9:
    v_and_b32 v99, 32, v1
    v_lshlrev_b32 v99, 1, v99
    v_sub_u32 v99, s66, v99
    v_mov_b32 v100, 0xfffff800
    v_lshlrev_b32 v4, 5, v3
    v_lshl_add_u32 v4, v2, 3, v4
    v_add_u32 v93, s62, v4
    v_add_u32 v94, s62, v97
    v_add_u32 v96, 92160, v97
    s_lshr_b32 s26, s23, 1
    v_lshlrev_b32 v4, 2, v2
    v_xor_b32 v4, v4, v3
    v_and_b32 v4, 7, v4
    v_xor_b32 v4, s26, v4
    v_lshlrev_b32 v86, 4, v4
    v_lshl_add_u32 v86, v3, 11, v86
    v_lshl_add_u32 v86, v2, 9, v86
    s_and_b32 s26, s23, 1
    s_lshl_b32 s26, s26, 3
    s_add_u32 s26, s26, 59392
    v_add_u32 v86, s26, v86
    v_and_b32 v4, 8, v3
    v_xor_b32 v86, v4, v86
    v_xor_b32 v87, 16, v86
    v_xor_b32 v88, 32, v86
    v_xor_b32 v89, 48, v86
    s_lshl_b32 s26, s23, 1
    v_xor_b32 v4, v2, v3
    v_xor_b32 v4, s26, v4
    v_and_b32 v4, 7, v4
    v_lshlrev_b32 v90, 4, v4
    v_lshl_add_u32 v90, v3, 7, v90
    s_lshl_b32 s26, s23, 12
    s_add_u32 s26, s26, 59392
    v_add_u32 v90, s26, v90
    v_xor_b32 v91, 16, v90
    v_lshrrev_b32 v4, 2, v1
    v_mul_u32_u24 v92, 928, v4
    v_and_b32 v4, 3, v1
    v_mul_u32_u24 v4, 56, v4
    s_lshl_b32 s26, s23, 3
    v_add3_u32 v92, v92, v4, s26
    v_mul_u32_u24 v95, 112, v2
    s_lshl_b32 s26, s23, 4
    s_add_u32 s26, s26, 102400
    v_add_u32 v95, s26, v95
    s_lshl_b32 s26, s24, 1
    s_add_u32 s26, s26, s23
    s_and_b32 s26, s26, 7
    s_mul_i32 s64, s26, 3712
    s_mul_i32 s65, s59, 57344
    s_mul_i32 s27, s26, 3584
    s_add_u32 s65, s65, s27
    s_mul_i32 s26, s26, 512
    v_add_u32 v4, 3584, v6
    v_add_u32 v6, s26, v6
    v_cmp_gt_u32 vcc, 16, v1
    s_nop 1
    v_cndmask_b32 v6, v4, v6, vcc
    s_cmp_eq_u32 s23, 7
    s_cbranch_scc1 adaLN_cond__spectral_fnet__moe_arch_mod__prompt_kernel_p710
    v_lshlrev_b32 v4, 6, v3
    v_add_u32 v4, s60, v4
    v_cvt_f32_u32 v84, v4
    v_mul_f32 v84, 0x3a000000, v84
    v_lshlrev_b32 v4, 2, v2
    v_cvt_f32_u32 v85, v4
    v_mul_f32 v85, v85, v84
    v_fmamk_f32 v152, v84, 0x00000000, v85
    v_fmamk_f32 v153, v84, 0x3f800000, v85
    v_fmamk_f32 v154, v84, 0x40000000, v85
    v_fmamk_f32 v155, v84, 0x40400000, v85
    v_fmamk_f32 v156, v84, 0x41800000, v85
    v_fmamk_f32 v157, v84, 0x41880000, v85
    v_fmamk_f32 v158, v84, 0x41900000, v85
    v_fmamk_f32 v159, v84, 0x41980000, v85
    v_sin_f32 v160, v152
    v_cos_f32 v152, v152
    v_sin_f32 v161, v153
    v_cos_f32 v153, v153
    v_sin_f32 v162, v154
    v_cos_f32 v154, v154
    v_sin_f32 v163, v155
    v_cos_f32 v155, v155
    v_sin_f32 v164, v156
    v_cos_f32 v156, v156
    v_sin_f32 v165, v157
    v_cos_f32 v157, v157
    v_sin_f32 v166, v158
    v_cos_f32 v158, v158
    v_sin_f32 v167, v159
    v_cos_f32 v159, v159
    v_cvt_pk_bf16_f32 v12, v152, v153
    v_cvt_pk_bf16_f32 v16, -v160, -v161
    v_cvt_pk_bf16_f32 v13, v154, v155
    v_cvt_pk_bf16_f32 v17, -v162, -v163
    v_cvt_pk_bf16_f32 v14, v156, v157
    v_cvt_pk_bf16_f32 v18, -v164, -v165
    v_cvt_pk_bf16_f32 v15, v158, v159
    v_cvt_pk_bf16_f32 v19, -v166, -v167
    s_cmp_eq_u32 s61, 1
    s_cselect_b32 s67, 0, 0x80008000
    s_cselect_b32 s68, 0x80008000, 0
    s_cmp_eq_u32 s59, 0
    s_cbranch_scc1 adaLN_cond__spectral_fnet__moe_arch_mod__prompt_kernel_ns12
    v_xor_b32 v20, s67, v16
    v_xor_b32 v24, s68, v12
    v_xor_b32 v21, s67, v17
    v_xor_b32 v25, s68, v13
    v_xor_b32 v22, s67, v18
    v_xor_b32 v26, s68, v14
    v_xor_b32 v23, s67, v19
    v_xor_b32 v27, s68, v15
    s_branch adaLN_cond__spectral_fnet__moe_arch_mod__prompt_kernel_nx13
adaLN_cond__spectral_fnet__moe_arch_mod__prompt_kernel_ns12:
    s_cmp_eq_u32 s61, 1
    s_cselect_b32 s67, 0, -1
    s_cselect_b32 s68, -1, 0
    v_and_b32 v20, s68, v12
    v_and_b32 v24, s68, v16
    v_and_b32 v12, s67, v12
    v_and_b32 v16, s67, v16
    v_and_b32 v21, s68, v13
    v_and_b32 v25, s68, v17
    v_and_b32 v13, s67, v13
    v_and_b32 v17, s67, v17
    v_and_b32 v22, s68, v14
    v_and_b32 v26, s68, v18
    v_and_b32 v14, s67, v14
    v_and_b32 v18, s67, v18
    v_and_b32 v23, s68, v15
    v_and_b32 v27, s68, v19
    v_and_b32 v15, s67, v15
    v_and_b32 v19, s67, v19
adaLN_cond__spectral_fnet__moe_arch_mod__prompt_kernel_nx13:
    v_cvt_f32_u32 v84, v3
    v_mul_f32 v84, 0x3b124925, v84
    v_mul_u32_u24 v4, 28, v2
    s_lshl_b32 s26, s23, 2
    v_add_u32 v4, s26, v4
    v_cvt_f32_u32 v85, v4
    v_mul_f32 v85, v85, v84
    v_fmamk_f32 v104, v84, 0x00000000, v85
    v_fmamk_f32 v105, v84, 0x42e00000, v85
    v_fmamk_f32 v106, v84, 0x43600000, v85
    v_fmamk_f32 v107, v84, 0x43a80000, v85
    v_fmamk_f32 v108, v84, 0x3f800000, v85
    v_fmamk_f32 v109, v84, 0x42e20000, v85
    v_fmamk_f32 v110, v84, 0x43610000, v85
    v_fmamk_f32 v111, v84, 0x43a88000, v85
    v_fmamk_f32 v112, v84, 0x40000000, v85
    v_fmamk_f32 v113, v84, 0x42e40000, v85
    v_fmamk_f32 v114, v84, 0x43620000, v85
    v_fmamk_f32 v115, v84, 0x43a90000, v85
    v_fmamk_f32 v116, v84, 0x40400000, v85
    v_fmamk_f32 v117, v84, 0x42e60000, v85
    v_fmamk_f32 v118, v84, 0x43630000, v85
    v_fmamk_f32 v119, v84, 0x43a98000, v85
    v_sin_f32 v120, v104
    v_cos_f32 v104, v104
    v_sin_f32 v121, v105
    v_cos_f32 v105, v105
    v_sin_f32 v122, v106
    v_cos_f32 v106, v106
    v_sin_f32 v123, v107
    v_cos_f32 v107, v107
    v_sin_f32 v124, v108
    v_cos_f32 v108, v108
    v_sin_f32 v125, v109
    v_cos_f32 v109, v109
    v_sin_f32 v126, v110
    v_cos_f32 v110, v110
    v_sin_f32 v127, v111
    v_cos_f32 v111, v111
    v_sin_f32 v128, v112
    v_cos_f32 v112, v112
    v_sin_f32 v129, v113
    v_cos_f32 v113, v113
    v_sin_f32 v130, v114
    v_cos_f32 v114, v114
    v_sin_f32 v131, v115
    v_cos_f32 v115, v115
    v_sin_f32 v132, v116
    v_cos_f32 v116, v116
    v_sin_f32 v133, v117
    v_cos_f32 v117, v117
    v_sin_f32 v134, v118
    v_cos_f32 v118, v118
    v_sin_f32 v135, v119
    v_cos_f32 v119, v119
    v_cvt_pk_bf16_f32 v44, v104, v105
    v_cvt_pk_bf16_f32 v45, v106, v107
    v_cvt_pk_bf16_f32 v46, v120, v121
    v_cvt_pk_bf16_f32 v47, v122, v123
    v_xor_b32 v48, 0x80008000, v44
    v_xor_b32 v49, 0x80008000, v45
    v_cvt_pk_bf16_f32 v50, v108, v109
    v_cvt_pk_bf16_f32 v51, v110, v111
    v_cvt_pk_bf16_f32 v52, v124, v125
    v_cvt_pk_bf16_f32 v53, v126, v127
    v_xor_b32 v54, 0x80008000, v50
    v_xor_b32 v55, 0x80008000, v51
    v_cvt_pk_bf16_f32 v56, v112, v113
    v_cvt_pk_bf16_f32 v57, v114, v115
    v_cvt_pk_bf16_f32 v58, v128, v129
    v_cvt_pk_bf16_f32 v59, v130, v131
    v_xor_b32 v60, 0x80008000, v56
    v_xor_b32 v61, 0x80008000, v57
    v_cvt_pk_bf16_f32 v62, v116, v117
    v_cvt_pk_bf16_f32 v63, v118, v119
    v_cvt_pk_bf16_f32 v64, v132, v133
    v_cvt_pk_bf16_f32 v65, v134, v135
    v_xor_b32 v66, 0x80008000, v62
    v_xor_b32 v67, 0x80008000, v63
    ds_read_b64 v[224:225], v93 offset:0
    ds_read_b64 v[226:227], v93 offset:512
    ds_read_b64 v[228:229], v93 offset:896
    ds_read_b64 v[230:231], v93 offset:1408
    v_cmp_gt_u32 vcc, 12, v3
    s_waitcnt lgkmcnt(0)
    s_nop 0
    v_cndmask_b32 v226, 0, v226, vcc
    v_cndmask_b32 v227, 0, v227, vcc
    v_cndmask_b32 v230, 0, v230, vcc
    v_cndmask_b32 v231, 0, v231, vcc
    v_lshlrev_b32 v68, 16, v224
    v_and_b32 v69, 0xffff0000, v224
    v_lshlrev_b32 v70, 16, v225
    v_and_b32 v71, 0xffff0000, v225
    v_lshlrev_b32 v72, 16, v226
    v_and_b32 v73, 0xffff0000, v226
    v_lshlrev_b32 v74, 16, v227
    v_and_b32 v75, 0xffff0000, v227
    v_lshlrev_b32 v76, 16, v228
    v_and_b32 v77, 0xffff0000, v228
    v_lshlrev_b32 v78, 16, v229
    v_and_b32 v79, 0xffff0000, v229
    v_lshlrev_b32 v80, 16, v230
    v_and_b32 v81, 0xffff0000, v230
    v_lshlrev_b32 v82, 16, v231
    v_and_b32 v83, 0xffff0000, v231
    s_mov_b32 s29, 0
    s_bfm_b64 exec, 16, 0
adaLN_cond__spectral_fnet__moe_arch_mod__prompt_kernel_pz14:
    buffer_load_dword v184, v6, s[40:43], s30 offen sc1
    s_add_u32 s29, s29, 1
    s_waitcnt vmcnt(0)
    v_cmp_ne_u32 vcc, s22, v184
    s_cbranch_vccz adaLN_cond__spectral_fnet__moe_arch_mod__prompt_kernel_pzd15
    s_sleep 1
    s_cmp_lt_u32 s29, 0x200000
    s_cbranch_scc1 adaLN_cond__spectral_fnet__moe_arch_mod__prompt_kernel_pz14
adaLN_cond__spectral_fnet__moe_arch_mod__prompt_kernel_pzd15:
    s_mov_b64 exec, -1
    s_bfm_b64 exec, 56, 0
    s_add_u32 s26, s64, 0
    s_add_u32 s27, s65, 0
    s_mov_b32 m0, s26
    s_nop 0
    buffer_load_dwordx4 v97, s[40:43], s27 offen sc1 lds
    s_add_u32 s26, s64, 928
    s_add_u32 s27, s65, 896
    s_mov_b32 m0, s26
    s_nop 0
    buffer_load_dwordx4 v97, s[40:43], s27 offen sc1 lds
    s_add_u32 s26, s64, 1856
    s_add_u32 s27, s65, 1792
    s_mov_b32 m0, s26
    s_nop 0
    buffer_load_dwordx4 v97, s[40:43], s27 offen sc1 lds
    s_add_u32 s26, s64, 2784
    s_add_u32 s27, s65, 2688
    s_mov_b32 m0, s26
    s_nop 0
    buffer_load_dwordx4 v97, s[40:43], s27 offen sc1 lds
    s_add_u32 s26, s64, 29696
    s_add_u32 s27, s65, 28672
    s_mov_b32 m0, s26
    s_nop 0
    buffer_load_dwordx4 v97, s[40:43], s27 offen sc1 lds
    s_add_u32 s26, s64, 30624
    s_add_u32 s27, s65, 29568
    s_mov_b32 m0, s26
    s_nop 0
    buffer_load_dwordx4 v97, s[40:43], s27 offen sc1 lds
    s_add_u32 s26, s64, 31552
    s_add_u32 s27, s65, 30464
    s_mov_b32 m0, s26
    s_nop 0
    buffer_load_dwordx4 v97, s[40:43], s27 offen sc1 lds
    s_add_u32 s26, s64, 32480
    s_add_u32 s27, s65, 31360
    s_mov_b32 m0, s26
    s_nop 0
    buffer_load_dwordx4 v97, s[40:43], s27 offen sc1 lds
    s_mov_b64 exec, -1
    v_mov_b32 v4, 105984
    v_mov_b32 v5, 1
    s_mov_b64 exec, 1
    s_waitcnt vmcnt(0)
    ds_add_u32 v4, v5 offset:8
    s_mov_b64 exec, -1
    s_branch adaLN_cond__spectral_fnet__moe_arch_mod__prompt_kernel_A11
adaLN_cond__spectral_fnet__moe_arch_mod__prompt_kernel_p710:
    v_lshlrev_b32 v240, 1, v240
    v_and_b32 v162, 3, v1
    v_lshlrev_b32 v162, 8, v162
    v_lshrrev_b32 v4, 2, v1
    v_lshl_add_u32 v162, v4, 4, v162
    v_add_u32 v162, 92160, v162
    s_mov_b32 s67, 0
    s_mov_b32 s68, 0
    s_mov_b32 s29, 0
    v_mov_b32 v136, 0
    v_mov_b32 v137, 0
    ds_write_b64 v86, v[136:137] offset:0
    v_xor_b32 v86, 64, v86
    ds_write_b64 v87, v[136:137] offset:128
    v_xor_b32 v87, 64, v87
    ds_write_b64 v88, v[136:137] offset:256
    v_xor_b32 v88, 64, v88
    ds_write_b64 v89, v[136:137] offset:384
    v_xor_b32 v89, 64, v89
    ds_write_b64 v86, v[136:137] offset:0
    ds_write_b64 v87, v[136:137] offset:128
    ds_write_b64 v88, v[136:137] offset:256
    ds_write_b64 v89, v[136:137] offset:384
    v_lshlrev_b32 v104, 16, v68
    v_and_b32 v105, 0xffff0000, v68
    v_lshlrev_b32 v106, 16, v69
    v_and_b32 v107, 0xffff0000, v69
    v_lshlrev_b32 v108, 16, v70
    v_and_b32 v109, 0xffff0000, v70
    v_lshlrev_b32 v110, 16, v71
    v_and_b32 v111, 0xffff0000, v71
    ds_read_b64 v[224:225], v93 offset:0
    ds_read_b64 v[226:227], v93 offset:512
    ds_read_b64 v[228:229], v93 offset:896
    ds_read_b64 v[230:231], v93 offset:1408
    v_cmp_gt_u32 vcc, 12, v3
    s_waitcnt lgkmcnt(0)
    s_nop 0
    v_cndmask_b32 v226, 0, v226, vcc
    v_cndmask_b32 v227, 0, v227, vcc
    v_cndmask_b32 v230, 0, v230, vcc
    v_cndmask_b32 v231, 0, v231, vcc
    v_lshlrev_b32 v68, 16, v224
    v_and_b32 v69, 0xffff0000, v224
    v_lshlrev_b32 v70, 16, v225
    v_and_b32 v71, 0xffff0000, v225
    v_lshlrev_b32 v72, 16, v226
    v_and_b32 v73, 0xffff0000, v226
    v_lshlrev_b32 v74, 16, v227
    v_and_b32 v75, 0xffff0000, v227
    v_lshlrev_b32 v76, 16, v228
    v_and_b32 v77, 0xffff0000, v228
    v_lshlrev_b32 v78, 16, v229
    v_and_b32 v79, 0xffff0000, v229
    v_lshlrev_b32 v80, 16, v230
    v_and_b32 v81, 0xffff0000, v230
    v_lshlrev_b32 v82, 16, v231
    v_and_b32 v83, 0xffff0000, v231
adaLN_cond__spectral_fnet__moe_arch_mod__prompt_kernel_l716:
    s_bfm_b64 exec, 58, 0
    buffer_load_dword v152, v6, s[40:43], s30 offen sc1
    s_add_u32 s29, s29, 1
    s_waitcnt vmcnt(0)
    v_cmp_ne_u32 vcc, s22, v152
    s_mov_b64 exec, -1
    s_cmp_ge_u32 s29, 0x200000
    s_cselect_b64 vcc, 0, vcc
    s_and_b32 s67, vcc_lo, 0xffff
    s_lshr_b64 s[70:71], vcc, 16
    s_or_b32 s70, s70, s68
    s_cmp_lg_u64 s[70:71], 0
    s_cbranch_scc1 adaLN_cond__spectral_fnet__moe_arch_mod__prompt_kernel_l7a17
    s_mov_b32 s68, 1
    s_mov_b32 m0, 102400
    s_mov_b32 s27, 1835008
    buffer_load_dwordx4 v97, s[40:43], s27 offen offset:0 sc1 lds
    buffer_load_dwordx4 v97, s[40:43], s27 offen offset:1024 sc1 lds
    buffer_load_dwordx4 v97, s[40:43], s27 offen offset:2048 sc1 lds
    s_bfm_b64 exec, 32, 0
    buffer_load_dwordx4 v97, s[40:43], s27 offen offset:3072 sc1 lds
    s_mov_b64 exec, -1
    s_mov_b32 s27, 1842176
    buffer_load_dwordx4 v[200:203], v97, s[40:43], s27 offen sc1
    buffer_load_dwordx4 v[204:207], v240, s[40:43], s27 offen sc1
    s_mov_b32 s27, 1840384
    buffer_load_dwordx4 v[208:211], v97, s[40:43], s27 offen sc1
    buffer_load_dwordx4 v[212:215], v240, s[40:43], s27 offen sc1
    s_mov_b32 s27, 1838592
    buffer_load_dwordx4 v[184:187], v97, s[40:43], s27 offen sc1
    buffer_load_dwordx4 v[188:191], v240, s[40:43], s27 offen sc1
    s_mov_b32 s27, 1843968
    buffer_load_dwordx4 v[216:219], v97, s[40:43], s27 offen sc1
    buffer_load_dwordx4 v[220:223], v240, s[40:43], s27 offen sc1
adaLN_cond__spectral_fnet__moe_arch_mod__prompt_kernel_l7a17:
    s_cmp_lg_u32 s67, 0
    s_cbranch_scc1 adaLN_cond__spectral_fnet__moe_arch_mod__prompt_kernel_l716
    s_bfm_b64 exec, 56, 0
    s_add_u32 s26, s64, 0
    s_add_u32 s27, s65, 0
    s_mov_b32 m0, s26
    s_nop 0
    buffer_load_dwordx4 v97, s[40:43], s27 offen sc1 lds
    s_add_u32 s26, s64, 928
    s_add_u32 s27, s65, 896
    s_mov_b32 m0, s26
    s_nop 0
    buffer_load_dwordx4 v97, s[40:43], s27 offen sc1 lds
    s_add_u32 s26, s64, 1856
    s_add_u32 s27, s65, 1792
    s_mov_b32 m0, s26
    s_nop 0
    buffer_load_dwordx4 v97, s[40:43], s27 offen sc1 lds
    s_add_u32 s26, s64, 2784
    s_add_u32 s27, s65, 2688
    s_mov_b32 m0, s26
    s_nop 0
    buffer_load_dwordx4 v97, s[40:43], s27 offen sc1 lds
    s_add_u32 s26, s64, 29696
    s_add_u32 s27, s65, 28672
    s_mov_b32 m0, s26
    s_nop 0
    buffer_load_dwordx4 v97, s[40:43], s27 offen sc1 lds
    s_add_u32 s26, s64, 30624
    s_add_u32 s27, s65, 29568
    s_mov_b32 m0, s26
    s_nop 0
    buffer_load_dwordx4 v97, s[40:43], s27 offen sc1 lds
    s_add_u32 s26, s64, 31552
    s_add_u32 s27, s65, 30464
    s_mov_b32 m0, s26
    s_nop 0
    buffer_load_dwordx4 v97, s[40:43], s27 offen sc1 lds
    s_add_u32 s26, s64, 32480
    s_add_u32 s27, s65, 31360
    s_mov_b32 m0, s26
    s_nop 0
    buffer_load_dwordx4 v97, s[40:43], s27 offen sc1 lds
    s_mov_b64 exec, -1
    s_cmp_eq_u32 s68, 1
    s_cbranch_scc1 adaLN_cond__spectral_fnet__moe_arch_mod__prompt_kernel_l7c19
    v_mov_b32 v4, 105984
adaLN_cond__spectral_fnet__moe_arch_mod__prompt_kernel_l7b18:
    s_bfm_b64 exec, 58, 0
    buffer_load_dword v152, v6, s[40:43], s30 offen sc1
    s_waitcnt vmcnt(0)
    ds_read_b32 v153, v4 offset:8
    v_cmp_ne_u32 vcc, s22, v152
    s_mov_b64 exec, -1
    s_cbranch_vccz adaLN_cond__spectral_fnet__moe_arch_mod__prompt_kernel_l7b18m
    s_waitcnt lgkmcnt(0)
    v_readfirstlane_b32 s26, v153
    s_nop 0
    s_cmp_lt_u32 s26, 7
    s_cbranch_scc1 adaLN_cond__spectral_fnet__moe_arch_mod__prompt_kernel_l7b18
    s_branch adaLN_cond__spectral_fnet__moe_arch_mod__prompt_kernel_A11
adaLN_cond__spectral_fnet__moe_arch_mod__prompt_kernel_l7b18m:
    s_mov_b32 s68, 1
    s_mov_b32 m0, 102400
    s_mov_b32 s27, 1835008
    buffer_load_dwordx4 v97, s[40:43], s27 offen offset:0 sc1 lds
    buffer_load_dwordx4 v97, s[40:43], s27 offen offset:1024 sc1 lds
    buffer_load_dwordx4 v97, s[40:43], s27 offen offset:2048 sc1 lds
    s_bfm_b64 exec, 32, 0
    buffer_load_dwordx4 v97, s[40:43], s27 offen offset:3072 sc1 lds
    s_mov_b64 exec, -1
    s_mov_b32 s27, 1842176
    buffer_load_dwordx4 v[200:203], v97, s[40:43], s27 offen sc1
    buffer_load_dwordx4 v[204:207], v240, s[40:43], s27 offen sc1
    s_mov_b32 s27, 1840384
    buffer_load_dwordx4 v[208:211], v97, s[40:43], s27 offen sc1
    buffer_load_dwordx4 v[212:215], v240, s[40:43], s27 offen sc1
    s_mov_b32 s27, 1838592
    buffer_load_dwordx4 v[184:187], v97, s[40:43], s27 offen sc1
    buffer_load_dwordx4 v[188:191], v240, s[40:43], s27 offen sc1
    s_mov_b32 s27, 1843968
    buffer_load_dwordx4 v[216:219], v97, s[40:43], s27 offen sc1
    buffer_load_dwordx4 v[220:223], v240, s[40:43], s27 offen sc1
    s_branch adaLN_cond__spectral_fnet__moe_arch_mod__prompt_kernel_A11
adaLN_cond__spectral_fnet__moe_arch_mod__prompt_kernel_l7c19:
    s_waitcnt vmcnt(0)
adaLN_cond__spectral_fnet__moe_arch_mod__prompt_kernel_A11:
    s_barrier
    s_cmp_eq_u32 s23, 7
    s_cbranch_scc1 adaLN_cond__spectral_fnet__moe_arch_mod__prompt_kernel_w720
    ds_read_b64_tr_b16 v[104:105], v92 offset:0
    ds_read_b64_tr_b16 v[106:107], v92 offset:14848
    ds_read_b64_tr_b16 v[108:109], v92 offset:29696
    ds_read_b64_tr_b16 v[110:111], v92 offset:44544
    ds_read_b64_tr_b16 v[112:113], v92 offset:224
    ds_read_b64_tr_b16 v[114:115], v92 offset:15072
    ds_read_b64_tr_b16 v[116:117], v92 offset:29920
    ds_read_b64_tr_b16 v[118:119], v92 offset:44768
    ds_read_b64_tr_b16 v[120:121], v92 offset:448
    ds_read_b64_tr_b16 v[122:123], v92 offset:15296
    ds_read_b64_tr_b16 v[124:125], v92 offset:30144
    ds_read_b64_tr_b16 v[126:127], v92 offset:44992
    ds_read_b64_tr_b16 v[128:129], v92 offset:672
    ds_read_b64_tr_b16 v[130:131], v92 offset:15520
    ds_read_b64_tr_b16 v[132:133], v92 offset:30368
    ds_read_b64_tr_b16 v[134:135], v92 offset:45216
    s_waitcnt lgkmcnt(12)
    v_mfma_f32_16x16x32_bf16 v[136:139], v[104:107], v[12:15], 0
    v_mfma_f32_16x16x32_bf16 v[136:139], v[108:111], v[20:23], v[136:139]
    s_waitcnt lgkmcnt(8)
    v_mfma_f32_16x16x32_bf16 v[140:143], v[112:115], v[12:15], 0
    v_mfma_f32_16x16x32_bf16 v[140:143], v[116:119], v[20:23], v[140:143]
    s_waitcnt lgkmcnt(4)
    v_mfma_f32_16x16x32_bf16 v[144:147], v[120:123], v[12:15], 0
    v_mfma_f32_16x16x32_bf16 v[144:147], v[124:127], v[20:23], v[144:147]
    s_waitcnt lgkmcnt(0)
    v_mfma_f32_16x16x32_bf16 v[148:151], v[128:131], v[12:15], 0
    v_mfma_f32_16x16x32_bf16 v[148:151], v[132:135], v[20:23], v[148:151]
    s_barrier
    ds_read_b128 v[168:171], v95 offset:1792
    ds_read_b128 v[172:175], v95 offset:2240
    ds_read_b128 v[176:179], v95 offset:2688
    ds_read_b128 v[180:183], v95 offset:3136
    v_mfma_f32_16x16x32_bf16 v[152:155], v[104:107], v[16:19], 0
    v_mfma_f32_16x16x32_bf16 v[152:155], v[108:111], v[24:27], v[152:155]
    v_mfma_f32_16x16x32_bf16 v[156:159], v[112:115], v[16:19], 0
    v_mfma_f32_16x16x32_bf16 v[156:159], v[116:119], v[24:27], v[156:159]
    s_waitcnt lgkmcnt(3)
    v_mul_f32 v136, v136, v168
    v_mul_f32 v137, v137, v169
    v_mul_f32 v138, v138, v170
    v_mul_f32 v139, v139, v171
    v_mfma_f32_16x16x32_bf16 v[160:163], v[120:123], v[16:19], 0
    v_mfma_f32_16x16x32_bf16 v[160:163], v[124:127], v[24:27], v[160:163]
    s_waitcnt lgkmcnt(2)
    v_mul_f32 v140, v140, v172
    v_mul_f32 v141, v141, v173
    v_mul_f32 v142, v142, v174
    v_mul_f32 v143, v143, v175
    v_mfma_f32_16x16x32_bf16 v[164:167], v[128:131], v[16:19], 0
    v_mfma_f32_16x16x32_bf16 v[164:167], v[132:135], v[24:27], v[164:167]
    s_waitcnt lgkmcnt(1)
    v_mul_f32 v144, v144, v176
    v_mul_f32 v145, v145, v177
    v_mul_f32 v146, v146, v178
    v_mul_f32 v147, v147, v179
    s_waitcnt lgkmcnt(0)
    v_mul_f32 v148, v148, v180
    v_mul_f32 v149, v149, v181
    v_mul_f32 v150, v150, v182
    v_mul_f32 v151, v151, v183
    s_cmp_eq_u32 s60, 0
    s_cbranch_scc1 adaLN_cond__spectral_fnet__moe_arch_mod__prompt_kernel_sa22
adaLN_cond__spectral_fnet__moe_arch_mod__prompt_kernel_sab23:
    v_cvt_pk_bf16_f32 v224, v136, v140
    v_cvt_pk_bf16_f32 v225, v144, v148
    v_cvt_pk_bf16_f32 v228, v137, v141
    v_cvt_pk_bf16_f32 v229, v145, v149
    v_cvt_pk_bf16_f32 v232, v138, v142
    v_cvt_pk_bf16_f32 v233, v146, v150
    v_cvt_pk_bf16_f32 v236, v139, v143
    v_cvt_pk_bf16_f32 v237, v147, v151
    v_mul_f32 v152, v152, v168
    v_mul_f32 v156, v156, v172
    v_mul_f32 v160, v160, v176
    v_mul_f32 v164, v164, v180
    v_cvt_pk_bf16_f32 v226, v152, v156
    v_cvt_pk_bf16_f32 v227, v160, v164
    v_mul_f32 v153, v153, v169
    v_mul_f32 v157, v157, v173
    v_mul_f32 v161, v161, v177
    v_mul_f32 v165, v165, v181
    v_cvt_pk_bf16_f32 v230, v153, v157
    v_cvt_pk_bf16_f32 v231, v161, v165
    v_mfma_f32_16x16x32_bf16 v[104:107], v[44:47], v[224:227], 0
    v_mfma_f32_16x16x32_bf16 v[120:123], v[46:49], v[224:227], 0
    v_mul_f32 v154, v154, v170
    v_mul_f32 v158, v158, v174
    v_mul_f32 v162, v162, v178
    v_mul_f32 v166, v166, v182
    v_cvt_pk_bf16_f32 v234, v154, v158
    v_cvt_pk_bf16_f32 v235, v162, v166
    v_mfma_f32_16x16x32_bf16 v[108:111], v[50:53], v[228:231], 0
    v_mfma_f32_16x16x32_bf16 v[124:127], v[52:55], v[228:231], 0
    v_mul_f32 v155, v155, v171
    v_mul_f32 v159, v159, v175
    v_mul_f32 v163, v163, v179
    v_mul_f32 v167, v167, v183
    v_cvt_pk_bf16_f32 v238, v155, v159
    v_cvt_pk_bf16_f32 v239, v163, v167
    v_mfma_f32_16x16x32_bf16 v[112:115], v[56:59], v[232:235], 0
    v_mfma_f32_16x16x32_bf16 v[128:131], v[58:61], v[232:235], 0
    v_mfma_f32_16x16x32_bf16 v[116:119], v[62:65], v[236:239], 0
    v_mfma_f32_16x16x32_bf16 v[132:135], v[64:67], v[236:239], 0
    v_cvt_pk_bf16_f32 v136, v104, v108
    v_cvt_pk_bf16_f32 v144, v120, v124
    v_cvt_pk_bf16_f32 v138, v105, v109
    v_cvt_pk_bf16_f32 v146, v121, v125
    v_cvt_pk_bf16_f32 v140, v106, v110
    v_cvt_pk_bf16_f32 v148, v122, v126
    v_cvt_pk_bf16_f32 v142, v107, v111
    v_cvt_pk_bf16_f32 v150, v123, v127
    v_cvt_pk_bf16_f32 v137, v112, v116
    ds_write_b64 v86, v[136:137] offset:0
    v_xor_b32 v86, 64, v86
    v_cvt_pk_bf16_f32 v139, v113, v117
    ds_write_b64 v87, v[138:139] offset:128
    v_xor_b32 v87, 64, v87
    v_cvt_pk_bf16_f32 v141, v114, v118
    ds_write_b64 v88, v[140:141] offset:256
    v_xor_b32 v88, 64, v88
    v_cvt_pk_bf16_f32 v143, v115, v119
    ds_write_b64 v89, v[142:143] offset:384
    v_xor_b32 v89, 64, v89
    v_cvt_pk_bf16_f32 v145, v128, v132
    ds_write_b64 v86, v[144:145] offset:0
    v_cvt_pk_bf16_f32 v147, v129, v133
    ds_write_b64 v87, v[146:147] offset:128
    v_cvt_pk_bf16_f32 v149, v130, v134
    ds_write_b64 v88, v[148:149] offset:256
    v_cvt_pk_bf16_f32 v151, v131, v135
    ds_write_b64 v89, v[150:151] offset:384
    s_branch adaLN_cond__spectral_fnet__moe_arch_mod__prompt_kernel_join21
adaLN_cond__spectral_fnet__moe_arch_mod__prompt_kernel_sa22:
    ds_read_b128 v[224:227], v95 offset:0
    ds_read_b128 v[228:231], v95 offset:448
    ds_read_b128 v[232:235], v95 offset:896
    ds_read_b128 v[236:239], v95 offset:1344
    s_mov_b32 exec_lo, 0x00010001
    s_mov_b32 exec_hi, 0x00010001
    s_waitcnt lgkmcnt(0)
    v_add_f32 v136, v136, v224
    v_add_f32 v137, v137, v225
    v_add_f32 v138, v138, v226
    v_add_f32 v139, v139, v227
    v_add_f32 v140, v140, v228
    v_add_f32 v141, v141, v229
    v_add_f32 v142, v142, v230
    v_add_f32 v143, v143, v231
    v_add_f32 v144, v144, v232
    v_add_f32 v145, v145, v233
    v_add_f32 v146, v146, v234
    v_add_f32 v147, v147, v235
    v_add_f32 v148, v148, v236
    v_add_f32 v149, v149, v237
    v_add_f32 v150, v150, v238
    v_add_f32 v151, v151, v239
    s_mov_b64 exec, -1
    s_nop 1
    s_branch adaLN_cond__spectral_fnet__moe_arch_mod__prompt_kernel_sab23
adaLN_cond__spectral_fnet__moe_arch_mod__prompt_kernel_w720:
    s_cmp_eq_u32 s68, 1
    s_cbranch_scc1 adaLN_cond__spectral_fnet__moe_arch_mod__prompt_kernel_l7m24
    v_mul_u32_u24 v6, 32, v1
    s_add_u32 s28, s30, 4096
    s_mov_b32 s29, 0
    s_bfm_b64 exec, 42, 0
adaLN_cond__spectral_fnet__moe_arch_mod__prompt_kernel_pm25:
    buffer_load_dword v152, v6, s[40:43], s28 offen sc1
    s_add_u32 s29, s29, 1
    s_waitcnt vmcnt(0)
    v_cmp_ne_u32 vcc, s22, v152
    s_cbranch_vccz adaLN_cond__spectral_fnet__moe_arch_mod__prompt_kernel_pmd26
    s_sleep 1
    s_cmp_lt_u32 s29, 0x200000
    s_cbranch_scc1 adaLN_cond__spectral_fnet__moe_arch_mod__prompt_kernel_pm25
adaLN_cond__spectral_fnet__moe_arch_mod__prompt_kernel_pmd26:
    s_mov_b64 exec, -1
    s_mov_b32 m0, 102400
    s_mov_b32 s27, 1835008
    buffer_load_dwordx4 v97, s[40:43], s27 offen offset:0 sc1 lds
    buffer_load_dwordx4 v97, s[40:43], s27 offen offset:1024 sc1 lds
    buffer_load_dwordx4 v97, s[40:43], s27 offen offset:2048 sc1 lds
    s_bfm_b64 exec, 32, 0
    buffer_load_dwordx4 v97, s[40:43], s27 offen offset:3072 sc1 lds
    s_mov_b64 exec, -1
    s_mov_b32 s27, 1842176
    buffer_load_dwordx4 v[200:203], v97, s[40:43], s27 offen sc1
    buffer_load_dwordx4 v[204:207], v240, s[40:43], s27 offen sc1
    s_mov_b32 s27, 1840384
    buffer_load_dwordx4 v[208:211], v97, s[40:43], s27 offen sc1
    buffer_load_dwordx4 v[212:215], v240, s[40:43], s27 offen sc1
    s_mov_b32 s27, 1838592
    buffer_load_dwordx4 v[184:187], v97, s[40:43], s27 offen sc1
    buffer_load_dwordx4 v[188:191], v240, s[40:43], s27 offen sc1
    s_mov_b32 s27, 1843968
    buffer_load_dwordx4 v[216:219], v97, s[40:43], s27 offen sc1
    buffer_load_dwordx4 v[220:223], v240, s[40:43], s27 offen sc1
adaLN_cond__spectral_fnet__moe_arch_mod__prompt_kernel_l7m24:
    s_waitcnt vmcnt(8)
    s_barrier
    s_waitcnt vmcnt(0)
    v_mul_f32 v192, v104, v200
    v_mul_f32 v193, v105, v201
    v_mul_f32 v194, v106, v202
    v_mul_f32 v195, v107, v203
    v_mul_f32 v196, v108, v204
    v_mul_f32 v197, v109, v205
    v_mul_f32 v198, v110, v206
    v_mul_f32 v199, v111, v207
    v_add_f32 v112, v192, v193
    v_mul_f32 v113, v104, v208
    v_add_f32 v112, v112, v194
    v_fmac_f32 v113, v105, v209
    v_add_f32 v112, v112, v195
    v_fmac_f32 v113, v106, v210
    v_add_f32 v112, v112, v196
    v_fmac_f32 v113, v107, v211
    v_add_f32 v112, v112, v197
    v_fmac_f32 v113, v108, v212
    v_add_f32 v112, v112, v198
    v_fmac_f32 v113, v109, v213
    v_add_f32 v112, v112, v199
    v_fmac_f32 v113, v110, v214
    v_fmac_f32 v113, v111, v215
    ds_write_b128 v162, v[200:203] offset:4096
    ds_write_b128 v162, v[204:207] offset:5120
    ds_write_b128 v162, v[208:211] offset:6144
    ds_write_b128 v162, v[212:215] offset:7168
    ds_write_b128 v162, v[184:187] offset:0
    ds_write_b128 v162, v[188:191] offset:1024
    ds_write_b128 v162, v[216:219] offset:8192
    ds_write_b128 v162, v[220:223] offset:9216
    v_permlane32_swap_b32 v112, v113
    v_add_f32 v112, v112, v113
    v_mov_b32 v113, v112
    s_nop 1
    v_permlane16_swap_b32 v112, v113
    v_add_f32 v112, v112, v113
    s_nop 1
    v_add_f32_dpp v112, v112, v112 row_ror:8 row_mask:0xf bank_mask:0xf
    s_nop 1
    v_add_f32_dpp v112, v112, v112 row_ror:4 row_mask:0xf bank_mask:0xf
    s_nop 1
    v_add_f32_dpp v112, v112, v112 row_ror:2 row_mask:0xf bank_mask:0xf
    s_nop 1
    v_add_f32_dpp v112, v112, v112 row_ror:1 row_mask:0xf bank_mask:0xf
    s_nop 0
    v_readlane_b32 s26, v112, 0
    v_readlane_b32 s27, v112, 32
    v_mov_b32 v113, 0xbb124925
    v_mul_f32 v113, s26, v113
    v_cmp_gt_u32 vcc, 48, v1
    s_nop 1
    v_cndmask_b32 v115, 0, v113, vcc
    v_mov_b32 v114, s27
    v_mov_b32 v5, 105984
    ds_write_b32 v5, v114 offset:4
    v_add_f32 v192, v192, v113
    v_add_f32 v193, v193, v113
    v_add_f32 v194, v194, v113
    v_add_f32 v195, v195, v113
    v_add_f32 v196, v196, v115
    v_add_f32 v197, v197, v115
    v_add_f32 v198, v198, v115
    v_add_f32 v199, v199, v115
    ds_write_b128 v162, v[192:195] offset:2048
    ds_write_b128 v162, v[196:199] offset:3072
adaLN_cond__spectral_fnet__moe_arch_mod__prompt_kernel_join21:
    v_xor_b32 v4, 64, v90
    v_xor_b32 v5, 64, v91
    v_mov_b32 v169, v8
    v_mov_b32 v171, v8
    v_mov_b32 v173, v8
    v_mov_b32 v175, v8
    s_waitcnt lgkmcnt(0)
    s_barrier
    ds_read_b128 v[104:107], v90
    ds_read_b128 v[108:111], v4
    ds_read_b128 v[112:115], v91 offset:2048
    ds_read_b128 v[116:119], v5 offset:2048
    s_mul_i32 s28, s2, 4096
    s_add_u32 s28, s28, 2097152
    s_mul_i32 s30, s2, 32
    s_add_u32 s30, s30, 2818048
    v_mul_u32_u24 v6, 16384, v1
    s_waitcnt lgkmcnt(3)
    v_mfma_f32_16x16x32_bf16 v[152:155], v[104:107], v[28:31], 0
    v_mfma_f32_16x16x32_bf16 v[156:159], v[104:107], v[36:39], 0
    ds_read_b128 v[184:187], v96 offset:0
    ds_read_b128 v[188:191], v96 offset:1024
    ds_read_b128 v[192:195], v96 offset:2048
    ds_read_b128 v[196:199], v96 offset:3072
    s_waitcnt lgkmcnt(6)
    v_mfma_f32_16x16x32_bf16 v[152:155], v[108:111], v[32:35], v[152:155]
    v_mfma_f32_16x16x32_bf16 v[156:159], v[108:111], v[40:43], v[156:159]
    s_waitcnt lgkmcnt(5)
    v_mfma_f32_16x16x32_bf16 v[160:163], v[112:115], v[28:31], 0
    v_mfma_f32_16x16x32_bf16 v[164:167], v[112:115], v[36:39], 0
    s_waitcnt lgkmcnt(4)
    v_mfma_f32_16x16x32_bf16 v[160:163], v[116:119], v[32:35], v[160:163]
    v_mfma_f32_16x16x32_bf16 v[164:167], v[116:119], v[40:43], v[164:167]
    ds_read_b128 v[200:203], v96 offset:4096
    ds_read_b128 v[204:207], v96 offset:5120
    ds_read_b128 v[208:211], v96 offset:6144
    ds_read_b128 v[212:215], v96 offset:7168
    ds_read_b128 v[216:219], v96 offset:8192
    ds_read_b128 v[220:223], v96 offset:9216
    v_mov_b32 v5, 105984
    ds_read_b32 v101, v5 offset:4
    s_waitcnt lgkmcnt(7)
    v_fmac_f32 v68, v184, v152
    v_mul_f32 v138, v68, v68
    v_mul_f32 v140, v68, v192
    v_fmac_f32 v69, v185, v153
    v_fmac_f32 v138, v69, v69
    v_fmac_f32 v140, v69, v193
    v_add_f32 v136, v68, v69
    v_fmac_f32 v70, v186, v154
    v_fmac_f32 v138, v70, v70
    v_fmac_f32 v140, v70, v194
    v_add_f32 v136, v136, v70
    v_fmac_f32 v71, v187, v155
    v_fmac_f32 v138, v71, v71
    v_fmac_f32 v140, v71, v195
    v_add_f32 v136, v136, v71
    v_fmac_f32 v72, v188, v156
    v_fmac_f32 v138, v72, v72
    v_fmac_f32 v140, v72, v196
    v_add_f32 v136, v136, v72
    v_fmac_f32 v73, v189, v157
    v_fmac_f32 v138, v73, v73
    v_fmac_f32 v140, v73, v197
    v_add_f32 v136, v136, v73
    v_fmac_f32 v74, v190, v158
    v_fmac_f32 v138, v74, v74
    v_fmac_f32 v140, v74, v198
    v_add_f32 v136, v136, v74
    v_fmac_f32 v75, v191, v159
    v_fmac_f32 v138, v75, v75
    v_fmac_f32 v140, v75, v199
    v_add_f32 v136, v136, v75
    v_fmac_f32 v76, v184, v160
    v_mul_f32 v139, v76, v76
    v_mul_f32 v141, v76, v192
    v_fmac_f32 v77, v185, v161
    v_fmac_f32 v139, v77, v77
    v_fmac_f32 v141, v77, v193
    v_add_f32 v137, v76, v77
    v_fmac_f32 v78, v186, v162
    v_fmac_f32 v139, v78, v78
    v_fmac_f32 v141, v78, v194
    v_add_f32 v137, v137, v78
    v_fmac_f32 v79, v187, v163
    v_fmac_f32 v139, v79, v79
    v_fmac_f32 v141, v79, v195
    v_add_f32 v137, v137, v79
    v_fmac_f32 v80, v188, v164
    v_fmac_f32 v139, v80, v80
    v_fmac_f32 v141, v80, v196
    v_add_f32 v137, v137, v80
    v_fmac_f32 v81, v189, v165
    v_fmac_f32 v139, v81, v81
    v_fmac_f32 v141, v81, v197
    v_add_f32 v137, v137, v81
    v_fmac_f32 v82, v190, v166
    v_fmac_f32 v139, v82, v82
    v_fmac_f32 v141, v82, v198
    v_add_f32 v137, v137, v82
    v_fmac_f32 v83, v191, v167
    v_fmac_f32 v139, v83, v83
    v_fmac_f32 v141, v83, v199
    v_add_f32 v137, v137, v83
    s_nop 0
    v_permlane32_swap_b32 v140, v141
    v_permlane32_swap_b32 v138, v139
    v_permlane32_swap_b32 v136, v137
    v_add_f32 v140, v140, v141
    v_add_f32 v138, v138, v139
    v_add_f32 v136, v136, v137
    v_mov_b32 v141, v140
    s_nop 0
    v_permlane16_swap_b32 v136, v138
    v_permlane16_swap_b32 v140, v141
    v_add_f32 v136, v136, v138
    v_add_f32 v140, v140, v141
    s_nop 0
    v_add_f32_dpp v136, v136, v136 row_ror:8 row_mask:0xf bank_mask:0xf
    v_add_f32_dpp v140, v140, v140 row_ror:8 row_mask:0xf bank_mask:0xf
    s_nop 0
    v_add_f32_dpp v136, v136, v136 row_ror:4 row_mask:0xf bank_mask:0xf
    v_add_f32_dpp v140, v140, v140 row_ror:4 row_mask:0xf bank_mask:0xf
    s_nop 0
    v_add_f32_dpp v136, v136, v136 row_ror:2 row_mask:0xf bank_mask:0xf
    v_add_f32_dpp v140, v140, v140 row_ror:2 row_mask:0xf bank_mask:0xf
    s_nop 0
    v_add_f32_dpp v136, v136, v136 row_ror:1 row_mask:0xf bank_mask:0xf
    v_add_f32_dpp v140, v140, v140 row_ror:1 row_mask:0xf bank_mask:0xf
    v_mov_b32 v138, v136
    s_nop 1
    v_permlane16_swap_b32 v136, v138
    s_waitcnt lgkmcnt(0)
    v_mul_f32 v136, 0x3b124925, v136
    v_mul_f32 v138, 0x3b124925, v138
    v_fma_f32 v138, -v136, v136, v138
    v_max_f32 v138, 0, v138
    v_add_f32 v138, 0x3727c5ac, v138
    v_rsq_f32 v138, v138
    s_nop 0
    v_mul_f32 v136, v136, v138
    v_fma_f32 v140, v140, v138, v101
    v_readlane_b32 s72, v138, 0
    v_ashrrev_i32 v4, 31, v140
    v_readlane_b32 s73, v138, 32
    v_or_b32 v4, 0x80000000, v4
    v_readlane_b32 s74, v136, 0
    v_xor_b32 v4, v4, v140
    v_readlane_b32 s75, v136, 32
    v_and_or_b32 v4, v4, v100, v99
    s_mov_b32 exec_lo, 1
    s_mov_b32 exec_hi, 1
    ds_max_u32 v5, v4
    s_mov_b64 exec, -1
    v_readlane_b32 s76, v4, 0
    v_readlane_b32 s77, v4, 32
    v_mov_b32 v145, v8
    s_waitcnt lgkmcnt(0)
    s_barrier
    ds_read_b32 v144, v5
    s_cmp_lg_u32 s23, 0
    s_cbranch_scc1 adaLN_cond__spectral_fnet__moe_arch_mod__prompt_kernel_k030
    s_mov_b64 exec, 0xff
    s_waitcnt lgkmcnt(0)
    buffer_store_dwordx2 v[144:145], v6, s[40:43], s30 offen sc1
    s_mov_b64 exec, -1
adaLN_cond__spectral_fnet__moe_arch_mod__prompt_kernel_k030:
    s_max_u32 s27, s76, s77
    s_cmp_gt_u32 s77, s76
    s_cbranch_scc1 adaLN_cond__spectral_fnet__moe_arch_mod__prompt_kernel_rb27
    v_mov_b32 v160, s74
    v_fma_f32 v152, v68, s72, -v160
    v_fma_f32 v153, v69, s72, -v160
    v_fma_f32 v154, v70, s72, -v160
    v_fma_f32 v155, v71, s72, -v160
    v_fma_f32 v156, v72, s72, -v160
    v_fma_f32 v157, v73, s72, -v160
    v_fma_f32 v158, v74, s72, -v160
    v_fma_f32 v159, v75, s72, -v160
    v_fma_f32 v104, v152, v200, v208
    v_fma_f32 v105, v153, v201, v209
    v_fma_f32 v106, v154, v202, v210
    v_fma_f32 v107, v155, v203, v211
    v_fma_f32 v108, v156, v204, v212
    v_fma_f32 v109, v157, v205, v213
    v_fma_f32 v110, v158, v206, v214
    v_fma_f32 v111, v159, v207, v215
    v_cvt_pk_bf16_f32 v168, v104, v105
    v_cvt_pk_bf16_f32 v170, v106, v107
    v_cvt_pk_bf16_f32 v172, v108, v109
    v_cvt_pk_bf16_f32 v174, v110, v111
    s_branch adaLN_cond__spectral_fnet__moe_arch_mod__prompt_kernel_rc28
adaLN_cond__spectral_fnet__moe_arch_mod__prompt_kernel_rb27:
    v_mov_b32 v160, s75
    v_fma_f32 v152, v76, s73, -v160
    v_fma_f32 v153, v77, s73, -v160
    v_fma_f32 v154, v78, s73, -v160
    v_fma_f32 v155, v79, s73, -v160
    v_fma_f32 v156, v80, s73, -v160
    v_fma_f32 v157, v81, s73, -v160
    v_fma_f32 v158, v82, s73, -v160
    v_fma_f32 v159, v83, s73, -v160
    v_fma_f32 v112, v152, v200, v208
    v_fma_f32 v113, v153, v201, v209
    v_fma_f32 v114, v154, v202, v210
    v_fma_f32 v115, v155, v203, v211
    v_fma_f32 v116, v156, v204, v212
    v_fma_f32 v117, v157, v205, v213
    v_fma_f32 v118, v158, v206, v214
    v_fma_f32 v119, v159, v207, v215
    v_cvt_pk_bf16_f32 v168, v112, v113
    v_cvt_pk_bf16_f32 v170, v114, v115
    v_cvt_pk_bf16_f32 v172, v116, v117
    v_cvt_pk_bf16_f32 v174, v118, v119
adaLN_cond__spectral_fnet__moe_arch_mod__prompt_kernel_rc28:
    s_waitcnt lgkmcnt(0)
    v_readfirstlane_b32 s78, v144
    s_nop 0
    s_cmp_lg_u32 s78, s27
    s_cbranch_scc1 adaLN_cond__spectral_fnet__moe_arch_mod__prompt_kernel_nw29
    buffer_store_dwordx4 v[168:171], v97, s[40:43], s28 offen sc1
    buffer_store_dwordx4 v[172:175], v97, s[40:43], s28 offen offset:1024 sc1
adaLN_cond__spectral_fnet__moe_arch_mod__prompt_kernel_nw29:
    s_cmp_gt_u32 s77, s76
    s_cbranch_scc1 adaLN_cond__spectral_fnet__moe_arch_mod__prompt_kernel_rd31
    v_mov_b32 v160, s75
    v_fma_f32 v152, v76, s73, -v160
    v_fma_f32 v153, v77, s73, -v160
    v_fma_f32 v154, v78, s73, -v160
    v_fma_f32 v155, v79, s73, -v160
    v_fma_f32 v156, v80, s73, -v160
    v_fma_f32 v157, v81, s73, -v160
    v_fma_f32 v158, v82, s73, -v160
    v_fma_f32 v159, v83, s73, -v160
    v_fma_f32 v112, v152, v200, v208
    v_fma_f32 v113, v153, v201, v209
    v_fma_f32 v114, v154, v202, v210
    v_fma_f32 v115, v155, v203, v211
    v_fma_f32 v116, v156, v204, v212
    v_fma_f32 v117, v157, v205, v213
    v_fma_f32 v118, v158, v206, v214
    v_fma_f32 v119, v159, v207, v215
    s_branch adaLN_cond__spectral_fnet__moe_arch_mod__prompt_kernel_re32
adaLN_cond__spectral_fnet__moe_arch_mod__prompt_kernel_rd31:
    v_mov_b32 v160, s74
    v_fma_f32 v152, v68, s72, -v160
    v_fma_f32 v153, v69, s72, -v160
    v_fma_f32 v154, v70, s72, -v160
    v_fma_f32 v155, v71, s72, -v160
    v_fma_f32 v156, v72, s72, -v160
    v_fma_f32 v157, v73, s72, -v160
    v_fma_f32 v158, v74, s72, -v160
    v_fma_f32 v159, v75, s72, -v160
    v_fma_f32 v104, v152, v200, v208
    v_fma_f32 v105, v153, v201, v209
    v_fma_f32 v106, v154, v202, v210
    v_fma_f32 v107, v155, v203, v211
    v_fma_f32 v108, v156, v204, v212
    v_fma_f32 v109, v157, v205, v213
    v_fma_f32 v110, v158, v206, v214
    v_fma_f32 v111, v159, v207, v215
adaLN_cond__spectral_fnet__moe_arch_mod__prompt_kernel_re32:
    v_fma_f32 v120, v216, v104, v68
    v_fma_f32 v121, v217, v105, v69
    v_fma_f32 v122, v218, v106, v70
    v_fma_f32 v123, v219, v107, v71
    v_fma_f32 v124, v220, v108, v72
    v_fma_f32 v125, v221, v109, v73
    v_fma_f32 v126, v222, v110, v74
    v_fma_f32 v127, v223, v111, v75
    v_fma_f32 v128, v216, v112, v76
    v_fma_f32 v129, v217, v113, v77
    v_fma_f32 v130, v218, v114, v78
    v_fma_f32 v131, v219, v115, v79
    v_fma_f32 v132, v220, v116, v80
    v_fma_f32 v133, v221, v117, v81
    v_fma_f32 v134, v222, v118, v82
    v_fma_f32 v135, v223, v119, v83
    v_cvt_pk_bf16_f32 v104, v120, v121
    v_cvt_pk_bf16_f32 v105, v122, v123
    v_cvt_pk_bf16_f32 v106, v124, v125
    v_cvt_pk_bf16_f32 v107, v126, v127
    v_cvt_pk_bf16_f32 v108, v128, v129
    v_cvt_pk_bf16_f32 v109, v130, v131
    v_cvt_pk_bf16_f32 v110, v132, v133
    v_cvt_pk_bf16_f32 v111, v134, v135
    ds_write_b64 v93, v[104:105]
    ds_write_b64 v93, v[108:109] offset:896
    s_mov_b32 exec_lo, 0x0fff0fff
    s_mov_b32 exec_hi, 0x0fff0fff
    ds_write_b64 v93, v[106:107] offset:512
    ds_write_b64 v93, v[110:111] offset:1408
    s_bfm_b64 exec, 56, 0
    s_waitcnt lgkmcnt(0)
    ds_read_b128 v[104:107], v94
    ds_read_b128 v[108:111], v94 offset:896
    s_add_u32 s26, s63, 57344
    s_waitcnt lgkmcnt(0)
    s_cmp_eq_u32 s78, s27
    s_cbranch_scc1 adaLN_cond__spectral_fnet__moe_arch_mod__prompt_kernel_end1w
    buffer_store_dwordx4 v[104:107], v97, s[44:47], s63 offen sc1
    buffer_store_dwordx4 v[108:111], v97, s[44:47], s26 offen sc1
    s_branch adaLN_cond__spectral_fnet__moe_arch_mod__prompt_kernel_end1
adaLN_cond__spectral_fnet__moe_arch_mod__prompt_kernel_end1w:
    buffer_store_dwordx4 v[104:107], v97, s[44:47], s63 offen sc1
    buffer_store_dwordx4 v[108:111], v97, s[44:47], s26 offen sc1
    s_waitcnt vmcnt(0)
    v_lshlrev_b32 v4, 2, v1
    s_bfm_b64 exec, 32, 0
    buffer_store_dword v8, v4, s[40:43], s28 offen offset:2048 sc1
    s_branch adaLN_cond__spectral_fnet__moe_arch_mod__prompt_kernel_end1
adaLN_cond__spectral_fnet__moe_arch_mod__prompt_kernel_sp5:
    s_waitcnt lgkmcnt(0)
    s_mov_b32 s48, s18
    s_mov_b32 s49, s19
    s_mov_b32 s50, 0x24c000
    s_mov_b32 s51, 0x00020000
    s_sub_u32 s26, s24, 16
    s_sub_u32 s27, s24, 18
    s_cmp_ge_u32 s24, 25
    s_cselect_b32 s27, s27, s26
    s_lshl_b32 s26, s26, 1
    s_lshl_b32 s27, s27, 2
    s_cmp_eq_u32 s25, 7
    s_cselect_b32 s26, s27, s26
    s_cselect_b32 s33, 4, 2
    s_cselect_b32 s27, 37, 52
    s_cselect_b32 s29, 7, 5
    s_add_u32 s26, s26, s23
    s_mul_i32 s27, s27, s26
    s_lshr_b32 s27, s27, 8
    s_mul_i32 s29, s29, s27
    s_sub_u32 s26, s26, s29
    s_lshl_b32 s29, s26, 3
    s_add_u32 s29, s29, s25
    s_add_u32 s28, s26, 35
    s_cmp_lt_u32 s26, 5
    s_cselect_b32 s29, s29, s28
    s_lshl_b32 s29, s29, 7
    s_sub_u32 s27, 6, s27
    s_mul_i32 s27, s27, 344064
    s_add_u32 s29, s29, s27
    s_cmp_lt_u32 s23, s33
    s_cselect_b32 s50, s50, 0
    v_mul_u32_u24 v4, 5376, v1
    buffer_load_dword v5, v4, s[48:51], s29 offen
    s_branch adaLN_cond__spectral_fnet__moe_arch_mod__prompt_kernel_end1
adaLN_cond__spectral_fnet__moe_arch_mod__prompt_kernel_G3:
    s_waitcnt lgkmcnt(0)
    s_add_u32 s26, s6, 1867776
    s_addc_u32 s27, s7, 0
    s_load_dword s22, s[26:27], 0
    s_waitcnt lgkmcnt(0)
    s_mov_b32 s48, s18
    s_mov_b32 s49, s19
    s_mov_b32 s50, 0x24c000
    s_mov_b32 s51, 0x00020000
    s_sub_u32 s26, s24, 16
    s_sub_u32 s27, s24, 18
    s_cmp_ge_u32 s24, 25
    s_cselect_b32 s27, s27, s26
    s_lshl_b32 s26, s26, 1
    s_lshl_b32 s27, s27, 2
    s_cmp_eq_u32 s25, 7
    s_cselect_b32 s26, s27, s26
    s_cselect_b32 s33, 4, 2
    s_cselect_b32 s27, 37, 52
    s_cselect_b32 s29, 7, 5
    s_add_u32 s26, s26, s23
    s_mul_i32 s27, s27, s26
    s_lshr_b32 s27, s27, 8
    s_mul_i32 s29, s29, s27
    s_sub_u32 s26, s26, s29
    s_lshl_b32 s29, s26, 3
    s_add_u32 s29, s29, s25
    s_add_u32 s28, s26, 35
    s_cmp_lt_u32 s26, 5
    s_cselect_b32 s29, s29, s28
    s_lshl_b32 s29, s29, 7
    s_sub_u32 s27, 6, s27
    s_mul_i32 s27, s27, 344064
    s_add_u32 s29, s29, s27
    s_cmp_lt_u32 s23, s33
    s_cselect_b32 s50, s50, 0
    v_mul_u32_u24 v4, 5376, v1
    buffer_load_dword v5, v4, s[48:51], s29 offen
    s_mov_b32 s40, s6
    s_mov_b32 s41, s7
    s_mov_b32 s42, 0x300000
    s_mov_b32 s43, 0x00020000
    s_mul_i32 s61, s25, 7
    s_add_u32 s61, s61, s24
    s_sub_u32 s61, s61, 16
    s_lshl_b32 s26, s61, 2
    s_xor_b32 s30, s23, s26
    s_and_b32 s30, s30, 7
    s_bitcmp1_b32 s30, 2
    s_cselect_b32 s44, s12, s10
    s_cselect_b32 s45, s13, s11
    s_mov_b32 s46, 1605632
    s_mov_b32 s47, 0x00020000
    v_lshrrev_b32 v4, 2, v1
    v_mul_u32_u24 v6, 3584, v4
    v_and_b32 v4, 3, v1
    v_lshl_add_u32 v6, v4, 4, v6
    s_and_b32 s26, s23, 3
    s_mul_i32 s28, s26, 401408
    s_lshl_b32 s27, s61, 6
    s_add_u32 s28, s28, s27
    s_mul_i32 s26, s30, 7168
    s_waitcnt vmcnt(0) lgkmcnt(0)
    s_barrier
    s_mov_b32 m0, s26
    s_add_u32 s26, s26, 1024
    buffer_load_dwordx4 v6, s[44:47], s28 offen  lds
    s_add_u32 s28, s28, 57344
    s_mov_b32 m0, s26
    s_add_u32 s26, s26, 1024
    buffer_load_dwordx4 v6, s[44:47], s28 offen  lds
    s_add_u32 s28, s28, 57344
    s_mov_b32 m0, s26
    s_add_u32 s26, s26, 1024
    buffer_load_dwordx4 v6, s[44:47], s28 offen  lds
    s_add_u32 s28, s28, 57344
    s_mov_b32 m0, s26
    s_add_u32 s26, s26, 1024
    buffer_load_dwordx4 v6, s[44:47], s28 offen  lds
    s_add_u32 s28, s28, 57344
    s_mov_b32 m0, s26
    s_add_u32 s26, s26, 1024
    buffer_load_dwordx4 v6, s[44:47], s28 offen  lds
    s_add_u32 s28, s28, 57344
    s_mov_b32 m0, s26
    s_add_u32 s26, s26, 1024
    buffer_load_dwordx4 v6, s[44:47], s28 offen  lds
    s_add_u32 s28, s28, 57344
    s_mov_b32 m0, s26
    s_add_u32 s26, s26, 1024
    buffer_load_dwordx4 v6, s[44:47], s28 offen  lds
    s_add_u32 s28, s28, 57344
    s_mul_i32 s22, s22, 0x9E3779B1
    s_add_u32 s22, s22, 0x7F4A7C15
    v_mov_b32 v8, s22
    v_mov_b32 v9, s22
    v_mov_b32 v10, s22
    v_mov_b32 v11, s22
    v_lshlrev_b32 v4, 9, v2
    v_bfe_u32 v5, v1, 2, 2
    v_lshl_add_u32 v4, v5, 6, v4
    v_and_b32 v5, 3, v1
    v_lshl_add_u32 v4, v5, 3, v4
    s_and_b32 s26, s23, 1
    s_mul_i32 s26, s26, 28672
    s_bfe_u32 s27, s23, 0x10001
    s_lshl_b32 s27, s27, 5
    s_add_u32 s26, s26, s27
    s_lshr_b32 s27, s23, 2
    s_mul_i32 s29, s27, 448
    s_mul_i32 s27, s27, 14336
    s_add_u32 s26, s26, s27
    v_add_u32 v4, s26, v4
    s_add_u32 s29, s29, 57344
    v_lshl_add_u32 v90, v2, 4, s29
    v_bfe_u32 v91, v1, 4, 1
    v_lshlrev_b32 v91, 7, v91
    v_lshl_add_u32 v91, v3, 2, v91
    s_lshl_b32 s26, s23, 6
    s_add_u32 s26, s26, 61440
    v_lshl_add_u32 v92, v2, 4, s26
    v_mul_u32_u24 v93, 8192, v2
    v_lshl_add_u32 v93, v3, 3, v93
    v_lshlrev_b32 v94, 3, v3
    s_lshl_b32 s79, s61, 7
    s_add_u32 s79, s79, 2031616
    s_add_u32 s80, s79, 32768
    v_mov_b32 v89, v8
    v_mov_b32 v84, 0
    v_mov_b32 v85, 0
    v_mov_b32 v86, 62464
    ds_write_b64 v86, v[84:85]
    s_waitcnt vmcnt(0) lgkmcnt(0)
    s_barrier
    ds_read_b64_tr_b16 v[12:13], v4 offset:0
    ds_read_b64_tr_b16 v[14:15], v4 offset:256
    ds_read_b64_tr_b16 v[16:17], v4 offset:2048
    ds_read_b64_tr_b16 v[18:19], v4 offset:2304
    ds_read_b64_tr_b16 v[20:21], v4 offset:4096
    ds_read_b64_tr_b16 v[22:23], v4 offset:4352
    ds_read_b64_tr_b16 v[24:25], v4 offset:6144
    ds_read_b64_tr_b16 v[26:27], v4 offset:6400
    ds_read_b64_tr_b16 v[28:29], v4 offset:8192
    ds_read_b64_tr_b16 v[30:31], v4 offset:8448
    ds_read_b64_tr_b16 v[32:33], v4 offset:10240
    ds_read_b64_tr_b16 v[34:35], v4 offset:10496
    ds_read_b64_tr_b16 v[36:37], v4 offset:12288
    ds_read_b64_tr_b16 v[38:39], v4 offset:12544
    v_mov_b32 v95, 62464
    s_cmp_eq_u32 s23, 7
    s_cbranch_scc1 adaLN_cond__spectral_fnet__moe_arch_mod__prompt_kernel_w135
    s_cmp_ge_u32 s23, 4
    s_cbranch_scc1 adaLN_cond__spectral_fnet__moe_arch_mod__prompt_kernel_g133
    v_mul_u32_u24 v4, 32, v1
    s_mul_i32 s33, s25, 16384
    s_mul_i32 s26, s23, 1024
    s_add_u32 s33, s33, s26
    s_add_u32 s33, s33, 2818048
    s_cmp_eq_u32 s23, 3
    s_cselect_b32 s26, 32, 32
    s_bfm_b64 s[72:73], s26, 0
    s_mov_b32 s29, 0
    v_mov_b32 v42, 1
adaLN_cond__spectral_fnet__moe_arch_mod__prompt_kernel_gp34:
    s_mov_b64 exec, s[72:73]
    buffer_load_dwordx2 v[40:41], v4, s[40:43], s33 offen sc1
    s_add_u32 s29, s29, 1
    s_waitcnt vmcnt(0)
    v_cmp_eq_u32 vcc, s22, v41
    s_nop 0
    s_andn2_b64 s[72:73], s[72:73], vcc
    s_mov_b64 exec, vcc
    ds_max_u32 v95, v40
    s_cmp_ge_u32 s29, 0x200000
    s_cselect_b64 s[72:73], 0, s[72:73]
    s_cmp_lg_u64 s[72:73], 0
    s_cbranch_scc1 adaLN_cond__spectral_fnet__moe_arch_mod__prompt_kernel_gp34
    s_mov_b64 exec, 1
    ds_add_u32 v95, v42 offset:4
    s_mov_b64 exec, -1
    s_branch adaLN_cond__spectral_fnet__moe_arch_mod__prompt_kernel_g133
adaLN_cond__spectral_fnet__moe_arch_mod__prompt_kernel_w135:
    v_lshlrev_b32 v6, 4, v1
    v_lshlrev_b32 v85, 5, v3
    v_lshl_add_u32 v85, v2, 3, v85
    v_add_u32 v85, 57344, v85
    s_mov_b32 s81, 0
    s_mov_b32 s29, 0
adaLN_cond__spectral_fnet__moe_arch_mod__prompt_kernel_r36:
    ds_read_b64 v[40:41], v95
    s_add_u32 s29, s29, 1
    s_cmp_ge_u32 s29, 0x2000000
    s_cbranch_scc1 adaLN_cond__spectral_fnet__moe_arch_mod__prompt_kernel_g133
    s_waitcnt lgkmcnt(0)
    v_readfirstlane_b32 s32, v40
    v_readfirstlane_b32 s26, v41
    s_cmp_lg_u32 s32, s81
    s_cbranch_scc1 adaLN_cond__spectral_fnet__moe_arch_mod__prompt_kernel_rs37
    s_cmp_lg_u32 s26, 4
    s_cbranch_scc1 adaLN_cond__spectral_fnet__moe_arch_mod__prompt_kernel_r36
    s_branch adaLN_cond__spectral_fnet__moe_arch_mod__prompt_kernel_g133
adaLN_cond__spectral_fnet__moe_arch_mod__prompt_kernel_rs37:
    s_and_b32 s30, s32, 2047
    s_sub_u32 s30, 2047, s30
    s_and_b32 s26, s30, 63
    s_sub_u32 s27, 64, s26
    s_and_b32 s27, s27, 31
    s_cmp_ge_u32 s26, 32
    s_cselect_b32 s26, s27, s26
    s_cselect_b32 s27, 16, 0
    s_and_b32 s31, s26, 7
    s_add_u32 s31, s31, s27
    s_lshr_b32 s26, s26, 3
    s_lshl_b32 s26, s26, 5
    s_add_u32 s31, s31, s26
    s_lshr_b32 s26, s30, 10
    s_lshl_b32 s26, s26, 3
    s_add_u32 s31, s31, s26
    s_mul_i32 s31, s31, 4096
    s_add_u32 s31, s31, 2097152
    buffer_load_dwordx4 v[44:47], v6, s[40:43], s31 offen sc1
    buffer_load_dwordx4 v[48:51], v6, s[40:43], s31 offen offset:1024 sc1
    s_waitcnt vmcnt(0)
    v_xor_b32 v7, s22, v45
    v_xor_b32 v5, s22, v47
    v_or_b32 v7, v7, v5
    v_xor_b32 v5, s22, v49
    v_or_b32 v7, v7, v5
    v_xor_b32 v5, s22, v51
    v_or_b32 v7, v7, v5
    v_cmp_ne_u32 vcc, 0, v7
    s_cbranch_vccnz adaLN_cond__spectral_fnet__moe_arch_mod__prompt_kernel_r36
    s_mov_b32 s81, s32
    v_mov_b32 v45, v46
    v_mov_b32 v49, v50
    ds_write_b64 v85, v[44:45]
    ds_write_b64 v85, v[48:49] offset:512
    s_branch adaLN_cond__spectral_fnet__moe_arch_mod__prompt_kernel_r36
adaLN_cond__spectral_fnet__moe_arch_mod__prompt_kernel_g133:
    s_waitcnt lgkmcnt(0)
    s_barrier
    ds_read_b128 v[52:55], v90 offset:0
    ds_read_b128 v[56:59], v90 offset:64
    ds_read_b128 v[60:63], v90 offset:128
    ds_read_b128 v[64:67], v90 offset:192
    ds_read_b128 v[68:71], v90 offset:256
    ds_read_b128 v[72:75], v90 offset:320
    ds_read_b128 v[76:79], v90 offset:384
    s_waitcnt lgkmcnt(6)
    v_mfma_f32_16x16x32_bf16 v[80:83], v[12:15], v[52:55], 0
    s_waitcnt lgkmcnt(5)
    v_mfma_f32_16x16x32_bf16 v[80:83], v[16:19], v[56:59], v[80:83]
    s_waitcnt lgkmcnt(4)
    v_mfma_f32_16x16x32_bf16 v[80:83], v[20:23], v[60:63], v[80:83]
    s_waitcnt lgkmcnt(3)
    v_mfma_f32_16x16x32_bf16 v[80:83], v[24:27], v[64:67], v[80:83]
    s_waitcnt lgkmcnt(2)
    v_mfma_f32_16x16x32_bf16 v[80:83], v[28:31], v[68:71], v[80:83]
    s_waitcnt lgkmcnt(1)
    v_mfma_f32_16x16x32_bf16 v[80:83], v[32:35], v[72:75], v[80:83]
    s_waitcnt lgkmcnt(0)
    v_mfma_f32_16x16x32_bf16 v[80:83], v[36:39], v[76:79], v[80:83]
    s_mov_b32 exec_lo, 0x00010001
    s_mov_b32 exec_hi, 0x00010001
    s_nop 5
    ds_write_b128 v92, v[80:83]
    s_mov_b64 exec, -1
    s_waitcnt lgkmcnt(0)
    s_barrier
    s_cmp_lg_u32 s23, 0
    s_cbranch_scc1 adaLN_cond__spectral_fnet__moe_arch_mod__prompt_kernel_end1
    ds_read_b32 v84, v91 offset:61440
    ds_read_b32 v85, v91 offset:61696
    ds_read_b32 v86, v91 offset:61504
    ds_read_b32 v87, v91 offset:61760
    s_waitcnt lgkmcnt(2)
    v_add_f32 v84, v84, v85
    v_cvt_pk_bf16_f32 v84, v84, v84
    v_and_b32 v84, 0xffff0000, v84
    v_mul_f32 v85, 0xbfb8aa3b, v84
    v_exp_f32 v85, v85
    s_waitcnt lgkmcnt(0)
    v_add_f32 v86, v86, v87
    v_add_f32 v85, 1.0, v85
    v_rcp_f32 v85, v85
    v_cvt_pk_bf16_f32 v86, v86, v86
    v_and_b32 v86, 0xffff0000, v86
    v_mul_f32 v84, v84, v85
    v_cvt_pk_bf16_f32 v84, v84, v84
    v_and_b32 v84, 0xffff0000, v84
    v_mul_f32 v84, v84, v86
    s_nop 1
    v_mov_b32_dpp v85, v84 quad_perm:[1,0,3,2] row_mask:0xf bank_mask:0xf
    v_cvt_pk_bf16_f32 v88, v84, v85
    ds_bpermute_b32 v88, v94, v88
    s_waitcnt lgkmcnt(0)
    buffer_store_dwordx2 v[88:89], v93, s[40:43], s79 offen sc1
    buffer_store_dwordx2 v[88:89], v93, s[40:43], s80 offen sc1
    s_branch adaLN_cond__spectral_fnet__moe_arch_mod__prompt_kernel_end1
adaLN_cond__spectral_fnet__moe_arch_mod__prompt_kernel_D4:
    s_waitcnt lgkmcnt(0)
    s_add_u32 s26, s6, 1867776
    s_addc_u32 s27, s7, 0
    s_load_dword s22, s[26:27], 0
    s_waitcnt lgkmcnt(0)
    s_mov_b32 s48, s18
    s_mov_b32 s49, s19
    s_mov_b32 s50, 0x24c000
    s_mov_b32 s51, 0x00020000
    s_sub_u32 s26, s24, 16
    s_sub_u32 s27, s24, 18
    s_cmp_ge_u32 s24, 25
    s_cselect_b32 s27, s27, s26
    s_lshl_b32 s26, s26, 1
    s_lshl_b32 s27, s27, 2
    s_cmp_eq_u32 s25, 7
    s_cselect_b32 s26, s27, s26
    s_cselect_b32 s33, 4, 2
    s_cselect_b32 s27, 37, 52
    s_cselect_b32 s29, 7, 5
    s_add_u32 s26, s26, s23
    s_mul_i32 s27, s27, s26
    s_lshr_b32 s27, s27, 8
    s_mul_i32 s29, s29, s27
    s_sub_u32 s26, s26, s29
    s_lshl_b32 s29, s26, 3
    s_add_u32 s29, s29, s25
    s_add_u32 s28, s26, 35
    s_cmp_lt_u32 s26, 5
    s_cselect_b32 s29, s29, s28
    s_lshl_b32 s29, s29, 7
    s_sub_u32 s27, 6, s27
    s_mul_i32 s27, s27, 344064
    s_add_u32 s29, s29, s27
    s_cmp_lt_u32 s23, s33
    s_cselect_b32 s50, s50, 0
    v_mul_u32_u24 v4, 5376, v1
    buffer_load_dword v5, v4, s[48:51], s29 offen
    s_mov_b32 s40, s6
    s_mov_b32 s41, s7
    s_mov_b32 s42, 0x300000
    s_mov_b32 s43, 0x00020000
    s_lshl_b32 s61, s25, 2
    s_add_u32 s61, s61, s24
    s_sub_u32 s61, s61, 23
    s_mov_b32 s44, s14
    s_mov_b32 s45, s15
    s_mov_b32 s46, 0x188000
    s_mov_b32 s47, 0x00020000
    s_mov_b32 s48, s20
    s_mov_b32 s49, s21
    s_mov_b32 s50, 0x1c0000
    s_mov_b32 s51, 0x00020000
    v_lshrrev_b32 v4, 1, v1
    v_mul_u32_u24 v6, 896, v4
    v_and_b32 v4, 1, v1
    v_lshl_add_u32 v6, v4, 4, v6
    s_lshl_b32 s26, s61, 1
    s_add_u32 s31, s23, s26
    s_and_b32 s31, s31, 7
    s_mul_i32 s28, s31, 200704
    s_lshl_b32 s27, s61, 5
    s_add_u32 s28, s28, s27
    s_mul_i32 s26, s23, 7168
    v_lshlrev_b32 v88, 1, v3
    s_mov_b32 s81, 1072693248
    s_waitcnt vmcnt(0) lgkmcnt(0)
    s_barrier
    s_mov_b32 m0, s26
    s_add_u32 s26, s26, 1024
    buffer_load_dwordx4 v6, s[44:47], s28 offen  lds
    s_add_u32 s28, s28, 28672
    s_mov_b32 m0, s26
    s_add_u32 s26, s26, 1024
    buffer_load_dwordx4 v6, s[44:47], s28 offen  lds
    s_add_u32 s28, s28, 28672
    s_mov_b32 m0, s26
    s_add_u32 s26, s26, 1024
    buffer_load_dwordx4 v6, s[44:47], s28 offen  lds
    s_add_u32 s28, s28, 28672
    s_mov_b32 m0, s26
    s_add_u32 s26, s26, 1024
    buffer_load_dwordx4 v6, s[44:47], s28 offen  lds
    s_add_u32 s28, s28, 28672
    s_mov_b32 m0, s26
    s_add_u32 s26, s26, 1024
    buffer_load_dwordx4 v6, s[44:47], s28 offen  lds
    s_add_u32 s28, s28, 28672
    s_mov_b32 m0, s26
    s_add_u32 s26, s26, 1024
    buffer_load_dwordx4 v6, s[44:47], s28 offen  lds
    s_add_u32 s28, s28, 28672
    s_mov_b32 m0, s26
    s_add_u32 s26, s26, 1024
    buffer_load_dwordx4 v6, s[44:47], s28 offen  lds
    s_add_u32 s28, s28, 28672
    s_mul_i32 s22, s22, 0x9E3779B1
    s_add_u32 s22, s22, 0x7F4A7C15
    v_mov_b32 v8, s22
    v_mov_b32 v9, s22
    v_mov_b32 v10, s22
    v_mov_b32 v11, s22
    s_cmp_lg_u32 s23, 1
    s_cbranch_scc1 adaLN_cond__spectral_fnet__moe_arch_mod__prompt_kernel_dr38
    s_lshl_b32 s26, s61, 5
    s_add_u32 s26, s26, 1871872
    v_mov_b32 v4, 0
    s_mov_b64 exec, 1
    buffer_store_dword v8, v4, s[40:43], s26 offen sc1
    s_mov_b64 exec, -1
adaLN_cond__spectral_fnet__moe_arch_mod__prompt_kernel_dr38:
    v_lshlrev_b32 v4, 8, v2
    v_lshl_add_u32 v4, v3, 3, v4
    s_mul_i32 s26, s23, 7168
    v_add_u32 v4, s26, v4
    s_mul_i32 s79, s31, 896
    s_add_u32 s79, s79, 2031616
    s_mul_i32 s26, s25, 8192
    s_add_u32 s79, s79, s26
    s_lshl_b32 s26, s23, 6
    s_add_u32 s26, s26, 61440
    v_lshl_add_u32 v92, v2, 4, s26
    v_lshlrev_b32 v94, 2, v3
    s_waitcnt vmcnt(0)
    ds_read_b64_tr_b16 v[12:13], v4 offset:0
    ds_read_b64_tr_b16 v[14:15], v4 offset:128
    ds_read_b64_tr_b16 v[16:17], v4 offset:1024
    ds_read_b64_tr_b16 v[18:19], v4 offset:1152
    ds_read_b64_tr_b16 v[20:21], v4 offset:2048
    ds_read_b64_tr_b16 v[22:23], v4 offset:2176
    ds_read_b64_tr_b16 v[24:25], v4 offset:3072
    ds_read_b64_tr_b16 v[26:27], v4 offset:3200
    ds_read_b64_tr_b16 v[28:29], v4 offset:4096
    ds_read_b64_tr_b16 v[30:31], v4 offset:4224
    ds_read_b64_tr_b16 v[32:33], v4 offset:5120
    ds_read_b64_tr_b16 v[34:35], v4 offset:5248
    ds_read_b64_tr_b16 v[36:37], v4 offset:6144
    ds_read_b64_tr_b16 v[38:39], v4 offset:6272
    s_cmp_lg_u32 s23, 0
    s_cbranch_scc1 adaLN_cond__spectral_fnet__moe_arch_mod__prompt_kernel_d139
    s_cmp_lg_u32 s61, 0
    s_cbranch_scc1 adaLN_cond__spectral_fnet__moe_arch_mod__prompt_kernel_d040
    v_lshlrev_b32 v4, 5, v1
    s_mov_b32 s33, 1871872
    s_mov_b32 s29, 0
    s_bfm_b64 exec, 28, 0
adaLN_cond__spectral_fnet__moe_arch_mod__prompt_kernel_pr41:
    buffer_load_dword v40, v4, s[40:43], s33 offen sc1
    s_add_u32 s29, s29, 1
    s_waitcnt vmcnt(0)
    v_cmp_ne_u32 vcc, s22, v40
    s_cbranch_vccz adaLN_cond__spectral_fnet__moe_arch_mod__prompt_kernel_prd42
    s_sleep 1
    s_cmp_lt_u32 s29, 0x200000
    s_cbranch_scc1 adaLN_cond__spectral_fnet__moe_arch_mod__prompt_kernel_pr41
adaLN_cond__spectral_fnet__moe_arch_mod__prompt_kernel_prd42:
    s_mov_b64 exec, -1
adaLN_cond__spectral_fnet__moe_arch_mod__prompt_kernel_d040:
    v_mul_u32_u24 v4, 32, v1
    s_mul_i32 s33, s25, 16384
    s_add_u32 s33, s33, 2818048
    s_add_u32 s28, s33, 2048
    s_mov_b32 s29, 0
adaLN_cond__spectral_fnet__moe_arch_mod__prompt_kernel_pk43:
    buffer_load_dwordx2 v[40:41], v4, s[40:43], s33 offen sc1
    buffer_load_dwordx2 v[42:43], v4, s[40:43], s28 offen sc1
    s_add_u32 s29, s29, 1
    s_waitcnt vmcnt(0)
    v_xor_b32 v7, s22, v41
    v_xor_b32 v5, s22, v43
    v_or_b32 v7, v7, v5
    v_cmp_ne_u32 vcc, 0, v7
    s_cbranch_vccz adaLN_cond__spectral_fnet__moe_arch_mod__prompt_kernel_pkd44
    s_sleep 1
    s_cmp_lt_u32 s29, 0x200000
    s_cbranch_scc1 adaLN_cond__spectral_fnet__moe_arch_mod__prompt_kernel_pk43
adaLN_cond__spectral_fnet__moe_arch_mod__prompt_kernel_pkd44:
    v_max_u32 v5, v40, v42
    s_nop 1
    v_max_u32_dpp v5, v5, v5 row_ror:8 row_mask:0xf bank_mask:0xf
    s_nop 1
    v_max_u32_dpp v5, v5, v5 row_ror:4 row_mask:0xf bank_mask:0xf
    s_nop 1
    v_max_u32_dpp v5, v5, v5 row_ror:2 row_mask:0xf bank_mask:0xf
    s_nop 1
    v_max_u32_dpp v5, v5, v5 row_ror:1 row_mask:0xf bank_mask:0xf
    s_nop 0
    v_readlane_b32 s32, v5, 0
    v_readlane_b32 s26, v5, 16
    v_readlane_b32 s27, v5, 32
    v_readlane_b32 s30, v5, 48
    s_max_u32 s32, s32, s26
    s_max_u32 s27, s27, s30
    s_max_u32 s32, s32, s27
    s_and_b32 s30, s32, 2047
    s_sub_u32 s30, 2047, s30
    s_and_b32 s26, s30, 63
    s_sub_u32 s27, 64, s26
    s_and_b32 s27, s27, 31
    s_cmp_ge_u32 s26, 32
    s_cselect_b32 s26, s27, s26
    s_cselect_b32 s27, 16, 0
    s_and_b32 s31, s26, 7
    s_add_u32 s31, s31, s27
    s_lshr_b32 s26, s26, 3
    s_lshl_b32 s26, s26, 5
    s_add_u32 s31, s31, s26
    s_lshr_b32 s26, s30, 10
    s_lshl_b32 s26, s26, 3
    s_add_u32 s31, s31, s26
    s_mul_i32 s31, s31, 4096
    s_add_u32 s31, s31, 2097152
    s_lshl_b32 s26, s61, 6
    s_add_u32 s28, s26, 1843968
    v_mov_b32 v91, 0
    buffer_load_dword v90, v94, s[40:43], s28 offen sc1
    s_and_b32 s26, s32, 0xfffff800
    s_or_b32 s26, s26, 0x400
    s_ashr_i32 s27, s26, 31
    s_not_b32 s27, s27
    s_or_b32 s27, s27, 0x80000000
    s_xor_b32 s26, s26, s27
    v_mov_b32 v86, s26
    v_cvt_pk_bf16_f32 v86, v86, v86
    v_and_b32 v86, 0xffff0000, v86
    v_mul_f32 v86, 0xbfb8aa3b, v86
    v_exp_f32 v86, v86
    s_nop 0
    v_add_f32 v86, 1.0, v86
    v_rcp_f32 v86, v86
    s_nop 0
    v_cvt_pk_bf16_f32 v86, v86, v86
    v_and_b32 v86, 0xffff0000, v86
    s_add_u32 s33, s31, 2048
    s_mov_b32 s29, 0
adaLN_cond__spectral_fnet__moe_arch_mod__prompt_kernel_pf45:
    buffer_load_dword v87, v91, s[40:43], s33 offen sc1
    s_add_u32 s29, s29, 1
    s_waitcnt vmcnt(0)
    v_cmp_ne_u32 vcc, s22, v87
    s_cbranch_vccz adaLN_cond__spectral_fnet__moe_arch_mod__prompt_kernel_pfd46
    s_sleep 1
    s_cmp_lt_u32 s29, 0x200000
    s_cbranch_scc1 adaLN_cond__spectral_fnet__moe_arch_mod__prompt_kernel_pf45
adaLN_cond__spectral_fnet__moe_arch_mod__prompt_kernel_pfd46:
    s_mul_i32 s81, s30, 896
    s_lshl_b32 s26, s61, 5
    s_add_u32 s81, s81, s26
    buffer_load_ushort v84, v88, s[48:51], s81 offen sc1
adaLN_cond__spectral_fnet__moe_arch_mod__prompt_kernel_d139:
    v_lshlrev_b32 v4, 4, v1
    s_lshl_b32 s26, s23, 9
    s_add_u32 s26, s26, 57344
    v_lshl_add_u32 v6, v1, 3, s26
    v_lshl_add_u32 v46, v2, 4, s26
    s_mov_b32 s29, 0
    s_bfm_b64 exec, 56, 0
adaLN_cond__spectral_fnet__moe_arch_mod__prompt_kernel_pg47:
    buffer_load_dwordx4 v[40:43], v4, s[40:43], s79 offen sc1
    s_add_u32 s29, s29, 1
    s_waitcnt vmcnt(0)
    v_xor_b32 v7, s22, v41
    v_xor_b32 v5, s22, v43
    v_or_b32 v7, v7, v5
    v_cmp_ne_u32 vcc, 0, v7
    s_cbranch_vccz adaLN_cond__spectral_fnet__moe_arch_mod__prompt_kernel_pgd48
    s_sleep 1
    s_cmp_lt_u32 s29, 0x200000
    s_cbranch_scc1 adaLN_cond__spectral_fnet__moe_arch_mod__prompt_kernel_pg47
adaLN_cond__spectral_fnet__moe_arch_mod__prompt_kernel_pgd48:
    s_mov_b64 exec, -1
    v_mov_b32 v41, v42
    ds_write_b64 v6, v[40:41]
    s_waitcnt lgkmcnt(0)
    ds_read_b128 v[48:51], v46 offset:0
    ds_read_b128 v[52:55], v46 offset:64
    ds_read_b128 v[56:59], v46 offset:128
    ds_read_b128 v[60:63], v46 offset:192
    ds_read_b128 v[64:67], v46 offset:256
    ds_read_b128 v[68:71], v46 offset:320
    ds_read_b128 v[72:75], v46 offset:384
    s_waitcnt lgkmcnt(6)
    v_mfma_f32_16x16x32_bf16 v[80:83], v[12:15], v[48:51], 0
    s_waitcnt lgkmcnt(5)
    v_mfma_f32_16x16x32_bf16 v[80:83], v[16:19], v[52:55], v[80:83]
    s_waitcnt lgkmcnt(4)
    v_mfma_f32_16x16x32_bf16 v[80:83], v[20:23], v[56:59], v[80:83]
    s_waitcnt lgkmcnt(3)
    v_mfma_f32_16x16x32_bf16 v[80:83], v[24:27], v[60:63], v[80:83]
    s_waitcnt lgkmcnt(2)
    v_mfma_f32_16x16x32_bf16 v[80:83], v[28:31], v[64:67], v[80:83]
    s_waitcnt lgkmcnt(1)
    v_mfma_f32_16x16x32_bf16 v[80:83], v[32:35], v[68:71], v[80:83]
    s_waitcnt lgkmcnt(0)
    v_mfma_f32_16x16x32_bf16 v[80:83], v[36:39], v[72:75], v[80:83]
    s_mov_b32 exec_lo, 0x00010001
    s_mov_b32 exec_hi, 0x00010001
    s_nop 5
    ds_write_b128 v92, v[80:83]
    s_mov_b64 exec, -1
    s_waitcnt lgkmcnt(0)
    s_barrier
    s_cmp_lg_u32 s23, 0
    s_cbranch_scc1 adaLN_cond__spectral_fnet__moe_arch_mod__prompt_kernel_end1
    ds_read_b32 v40, v94 offset:61440
    ds_read_b32 v41, v94 offset:61504
    ds_read_b32 v42, v94 offset:61568
    ds_read_b32 v43, v94 offset:61632
    ds_read_b32 v44, v94 offset:61696
    ds_read_b32 v45, v94 offset:61760
    ds_read_b32 v46, v94 offset:61824
    ds_read_b32 v47, v94 offset:61888
    v_lshlrev_b32 v84, 16, v84
    s_waitcnt lgkmcnt(6)
    v_add_f32 v40, v40, v41
    s_waitcnt lgkmcnt(4)
    v_add_f32 v42, v42, v43
    s_waitcnt lgkmcnt(2)
    v_add_f32 v44, v44, v45
    s_waitcnt lgkmcnt(0)
    v_add_f32 v46, v46, v47
    v_add_f32 v40, v40, v42
    v_add_f32 v44, v44, v46
    v_add_f32 v40, v40, v44
    v_cvt_pk_bf16_f32 v40, v40, v40
    v_and_b32 v40, 0xffff0000, v40
    v_mul_f32 v40, v40, v86
    v_cvt_pk_bf16_f32 v40, v40, v40
    v_and_b32 v40, 0xffff0000, v40
    v_fma_f32 v40, v40, v90, v84
    v_cvt_pk_bf16_f32 v40, v40, v40
    s_bfm_b64 exec, 16, 0
    buffer_store_short v40, v88, s[48:51], s81 offen sc1
    s_cmp_lg_u32 s61, 0
    s_cbranch_scc1 adaLN_cond__spectral_fnet__moe_arch_mod__prompt_kernel_end1
    s_mov_b64 exec, 1
    v_mov_b32 v4, 1867776
    buffer_store_dword v8, v4, s[40:43], 0 offen sc1
    s_branch adaLN_cond__spectral_fnet__moe_arch_mod__prompt_kernel_end1
adaLN_cond__spectral_fnet__moe_arch_mod__prompt_kernel_mod2:
    s_mul_i32 s26, s23, 56
    v_lshrrev_b32 v4, 3, v1
    v_add_u32 v5, s26, v4
    v_mul_u32_u24 v6, 5376, v5
    v_and_b32 v5, 7, v0
    v_lshl_add_u32 v6, v5, 4, v6
    v_add_u32 v7, s26, v1
    v_lshlrev_b32 v7, 1, v7
    s_lshl_b32 s28, s31, 7
    s_waitcnt lgkmcnt(0)
    s_mov_b32 s44, s16
    s_mov_b32 s45, s17
    s_mov_b32 s46, 0x380
    s_mov_b32 s47, 0x00020000
    s_mov_b32 s48, s18
    s_mov_b32 s49, s19
    s_mov_b32 s50, 0x24c000
    s_mov_b32 s51, 0x00020000
    s_add_u32 s26, s6, 1867776
    s_addc_u32 s27, s7, 0
    s_load_dword s22, s[26:27], 0
    s_waitcnt lgkmcnt(0)
    buffer_load_ushort v47, v7, s[44:47], 0 offen
    buffer_load_dwordx4 v[12:15], v6, s[48:51], s28 offen
    s_add_u32 s28, s28, 43008
    buffer_load_dwordx4 v[16:19], v6, s[48:51], s28 offen
    s_add_u32 s28, s28, 43008
    buffer_load_dwordx4 v[20:23], v6, s[48:51], s28 offen
    s_add_u32 s28, s28, 43008
    buffer_load_dwordx4 v[24:27], v6, s[48:51], s28 offen
    s_add_u32 s28, s28, 43008
    buffer_load_dwordx4 v[28:31], v6, s[48:51], s28 offen
    s_add_u32 s28, s28, 43008
    buffer_load_dwordx4 v[32:35], v6, s[48:51], s28 offen
    s_add_u32 s28, s28, 43008
    buffer_load_dwordx4 v[36:39], v6, s[48:51], s28 offen
    s_mov_b32 s40, s6
    s_mov_b32 s41, s7
    s_mov_b32 s42, 0x300000
    s_mov_b32 s43, 0x00020000
    v_lshlrev_b32 v7, 2, v4
    v_lshrrev_b32 v4, 6, v0
    v_lshlrev_b32 v64, 8, v4
    v_lshl_add_u32 v64, v5, 5, v64
    v_bfe_u32 v5, v0, 4, 1
    v_lshl_add_u32 v64, v5, 3, v64
    v_bfe_u32 v5, v0, 5, 1
    v_lshl_add_u32 v64, v5, 2, v64
    s_mul_i32 s27, s31, 37
    s_lshr_b32 s27, s27, 8
    s_cmp_eq_u32 s27, 0
    s_cselect_b32 s32, 0x45000000, 1.0
    s_cmp_eq_u32 s27, 1
    s_cselect_b32 s30, 1.0, 0
    s_cmp_eq_u32 s27, 4
    s_cselect_b32 s30, 1.0, s30
    s_lshl_b32 s28, s31, 8
    s_add_u32 s28, s28, 1835008
    s_add_u32 s33, s31, 128
    v_lshlrev_b32 v6, 2, v0
    s_mul_i32 s33, s33, 32
    s_add_u32 s33, s33, 2621440
    v_mul_u32_u24 v65, 24576, v1
    s_waitcnt vmcnt(7)
    v_lshlrev_b32 v47, 16, v47
    v_mul_f32 v48, 0xbfb8aa3b, v47
    v_exp_f32 v48, v48
    s_nop 0
    v_add_f32 v48, 1.0, v48
    v_rcp_f32 v48, v48
    s_nop 0
    v_mul_f32 v47, v47, v48
    v_cvt_pk_bf16_f32 v47, v47, v47
    v_and_b32 v47, 0xffff0000, v47
    ds_bpermute_b32 v40, v7, v47 offset:0
    ds_bpermute_b32 v41, v7, v47 offset:32
    ds_bpermute_b32 v42, v7, v47 offset:64
    ds_bpermute_b32 v43, v7, v47 offset:96
    ds_bpermute_b32 v44, v7, v47 offset:128
    ds_bpermute_b32 v45, v7, v47 offset:160
    ds_bpermute_b32 v46, v7, v47 offset:192
    s_waitcnt lgkmcnt(0)
    s_mul_i32 s22, s22, 0x9E3779B1
    s_add_u32 s22, s22, 0x7F4A7C15
    v_mov_b32 v8, s22
    v_mov_b32 v9, s22
    v_mov_b32 v10, s22
    v_mov_b32 v11, s22
    s_waitcnt vmcnt(6)
    v_lshlrev_b32 v48, 16, v12
    v_and_b32 v49, 0xffff0000, v12
    v_mul_f32 v56, v48, v40
    v_mul_f32 v57, v49, v40
    v_lshlrev_b32 v50, 16, v13
    v_and_b32 v51, 0xffff0000, v13
    v_mul_f32 v58, v50, v40
    v_mul_f32 v59, v51, v40
    v_lshlrev_b32 v48, 16, v14
    v_and_b32 v49, 0xffff0000, v14
    v_mul_f32 v60, v48, v40
    v_mul_f32 v61, v49, v40
    v_lshlrev_b32 v50, 16, v15
    v_and_b32 v51, 0xffff0000, v15
    v_mul_f32 v62, v50, v40
    v_mul_f32 v63, v51, v40
    s_waitcnt vmcnt(5)
    v_lshlrev_b32 v48, 16, v16
    v_and_b32 v49, 0xffff0000, v16
    v_fmac_f32 v56, v48, v41
    v_fmac_f32 v57, v49, v41
    v_lshlrev_b32 v50, 16, v17
    v_and_b32 v51, 0xffff0000, v17
    v_fmac_f32 v58, v50, v41
    v_fmac_f32 v59, v51, v41
    v_lshlrev_b32 v48, 16, v18
    v_and_b32 v49, 0xffff0000, v18
    v_fmac_f32 v60, v48, v41
    v_fmac_f32 v61, v49, v41
    v_lshlrev_b32 v50, 16, v19
    v_and_b32 v51, 0xffff0000, v19
    v_fmac_f32 v62, v50, v41
    v_fmac_f32 v63, v51, v41
    s_waitcnt vmcnt(4)
    v_lshlrev_b32 v48, 16, v20
    v_and_b32 v49, 0xffff0000, v20
    v_fmac_f32 v56, v48, v42
    v_fmac_f32 v57, v49, v42
    v_lshlrev_b32 v50, 16, v21
    v_and_b32 v51, 0xffff0000, v21
    v_fmac_f32 v58, v50, v42
    v_fmac_f32 v59, v51, v42
    v_lshlrev_b32 v48, 16, v22
    v_and_b32 v49, 0xffff0000, v22
    v_fmac_f32 v60, v48, v42
    v_fmac_f32 v61, v49, v42
    v_lshlrev_b32 v50, 16, v23
    v_and_b32 v51, 0xffff0000, v23
    v_fmac_f32 v62, v50, v42
    v_fmac_f32 v63, v51, v42
    s_waitcnt vmcnt(3)
    v_lshlrev_b32 v48, 16, v24
    v_and_b32 v49, 0xffff0000, v24
    v_fmac_f32 v56, v48, v43
    v_fmac_f32 v57, v49, v43
    v_lshlrev_b32 v50, 16, v25
    v_and_b32 v51, 0xffff0000, v25
    v_fmac_f32 v58, v50, v43
    v_fmac_f32 v59, v51, v43
    v_lshlrev_b32 v48, 16, v26
    v_and_b32 v49, 0xffff0000, v26
    v_fmac_f32 v60, v48, v43
    v_fmac_f32 v61, v49, v43
    v_lshlrev_b32 v50, 16, v27
    v_and_b32 v51, 0xffff0000, v27
    v_fmac_f32 v62, v50, v43
    v_fmac_f32 v63, v51, v43
    s_waitcnt vmcnt(2)
    v_lshlrev_b32 v48, 16, v28
    v_and_b32 v49, 0xffff0000, v28
    v_fmac_f32 v56, v48, v44
    v_fmac_f32 v57, v49, v44
    v_lshlrev_b32 v50, 16, v29
    v_and_b32 v51, 0xffff0000, v29
    v_fmac_f32 v58, v50, v44
    v_fmac_f32 v59, v51, v44
    v_lshlrev_b32 v48, 16, v30
    v_and_b32 v49, 0xffff0000, v30
    v_fmac_f32 v60, v48, v44
    v_fmac_f32 v61, v49, v44
    v_lshlrev_b32 v50, 16, v31
    v_and_b32 v51, 0xffff0000, v31
    v_fmac_f32 v62, v50, v44
    v_fmac_f32 v63, v51, v44
    s_waitcnt vmcnt(1)
    v_lshlrev_b32 v48, 16, v32
    v_and_b32 v49, 0xffff0000, v32
    v_fmac_f32 v56, v48, v45
    v_fmac_f32 v57, v49, v45
    v_lshlrev_b32 v50, 16, v33
    v_and_b32 v51, 0xffff0000, v33
    v_fmac_f32 v58, v50, v45
    v_fmac_f32 v59, v51, v45
    v_lshlrev_b32 v48, 16, v34
    v_and_b32 v49, 0xffff0000, v34
    v_fmac_f32 v60, v48, v45
    v_fmac_f32 v61, v49, v45
    v_lshlrev_b32 v50, 16, v35
    v_and_b32 v51, 0xffff0000, v35
    v_fmac_f32 v62, v50, v45
    v_fmac_f32 v63, v51, v45
    s_waitcnt vmcnt(0)
    v_lshlrev_b32 v48, 16, v36
    v_and_b32 v49, 0xffff0000, v36
    v_fmac_f32 v56, v48, v46
    v_fmac_f32 v57, v49, v46
    v_lshlrev_b32 v50, 16, v37
    v_and_b32 v51, 0xffff0000, v37
    v_fmac_f32 v58, v50, v46
    v_fmac_f32 v59, v51, v46
    v_lshlrev_b32 v48, 16, v38
    v_and_b32 v49, 0xffff0000, v38
    v_fmac_f32 v60, v48, v46
    v_fmac_f32 v61, v49, v46
    v_lshlrev_b32 v50, 16, v39
    v_and_b32 v51, 0xffff0000, v39
    v_fmac_f32 v62, v50, v46
    v_fmac_f32 v63, v51, v46
    v_permlane32_swap_b32 v56, v57
    v_permlane32_swap_b32 v58, v59
    v_permlane32_swap_b32 v60, v61
    v_permlane32_swap_b32 v62, v63
    v_add_f32 v56, v56, v57
    v_add_f32 v58, v58, v59
    v_add_f32 v60, v60, v61
    v_add_f32 v62, v62, v63
    v_permlane16_swap_b32 v56, v58
    s_nop 0
    v_permlane16_swap_b32 v60, v62
    v_add_f32 v56, v56, v58
    v_add_f32 v60, v60, v62
    s_nop 0
    v_add_f32_dpp v56, v56, v56 row_ror:8 row_mask:0xf bank_mask:0xf
    v_add_f32_dpp v60, v60, v60 row_ror:8 row_mask:0xf bank_mask:0xf
    ds_write_b32 v64, v56
    ds_write_b32 v64, v60 offset:16
    s_waitcnt lgkmcnt(0)
    s_barrier
    s_cmp_lg_u32 s23, 0
    s_cbranch_scc1 adaLN_cond__spectral_fnet__moe_arch_mod__prompt_kernel_end1
    ds_read_b32 v48, v6 offset:0
    ds_read_b32 v49, v6 offset:256
    ds_read_b32 v50, v6 offset:512
    ds_read_b32 v51, v6 offset:768
    ds_read_b32 v52, v6 offset:1024
    ds_read_b32 v53, v6 offset:1280
    ds_read_b32 v54, v6 offset:1536
    ds_read_b32 v55, v6 offset:1792
    s_waitcnt lgkmcnt(6)
    v_add_f32 v48, v48, v49
    s_waitcnt lgkmcnt(4)
    v_add_f32 v50, v50, v51
    s_waitcnt lgkmcnt(2)
    v_add_f32 v52, v52, v53
    s_waitcnt lgkmcnt(0)
    v_add_f32 v54, v54, v55
    v_add_f32 v48, v48, v50
    v_add_f32 v52, v52, v54
    v_add_f32 v48, v48, v52
    v_cvt_pk_bf16_f32 v48, v48, v48
    v_and_b32 v48, 0xffff0000, v48
    v_add_f32 v48, s30, v48
    v_cvt_pk_bf16_f32 v48, v48, v48
    v_and_b32 v48, 0xffff0000, v48
    v_mul_f32 v48, s32, v48
    buffer_store_dword v48, v6, s[40:43], s28 offen sc1
    s_waitcnt vmcnt(0)
    s_mov_b64 exec, 0xff
    buffer_store_dword v8, v65, s[40:43], s33 offen sc1
    s_mov_b64 exec, -1
    s_branch adaLN_cond__spectral_fnet__moe_arch_mod__prompt_kernel_end1
adaLN_cond__spectral_fnet__moe_arch_mod__prompt_kernel_end1:
    s_endpgm
.section .rodata,"a"
.p2align 6
.amdhsa_kernel adaLN_cond__spectral_fnet__moe_arch_mod__prompt_kernel
  .amdhsa_next_free_vgpr 248
  .amdhsa_next_free_sgpr 82
  .amdhsa_accum_offset 248
  .amdhsa_group_segment_fixed_size 0
  .amdhsa_kernarg_size 120
  .amdhsa_user_sgpr_count 2
  .amdhsa_user_sgpr_kernarg_segment_ptr 1
  .amdhsa_system_sgpr_workgroup_id_x 1
  .amdhsa_float_denorm_mode_32 3
.end_amdhsa_kernel
```
